```python
import torch

def _softmax(x, axis=-1):
    return torch.softmax(x, dim=axis)
def _gelu(x):
    return torch.nn.functional.gelu(x, approximate="tanh")
def _silu(x):
    return torch.nn.functional.silu(x)
def _sigmoid(x):
    return torch.sigmoid(x)
def _layernorm(x, axis=-1, eps=1e-5):
    m = x.mean(dim=axis, keepdim=True)
    v = x.var(dim=axis, keepdim=True, unbiased=False)
    return (x - m) / torch.sqrt(v + eps)
def _scatter_add(tgt, idx, src, axis=0):
    return tgt.clone().index_add_(axis, idx, src)
def _segment_sum(src, seg, n):
    out = torch.zeros((n,) + src.shape[1:], dtype=src.dtype)
    return out.index_add_(0, seg, src)
def _pad(x, pw):
    flat = tuple(v for pair in reversed(pw) for v in pair)
    return torch.nn.functional.pad(x, flat)

kernel_name = 'recurrent_scan__mha_block_cached__geglu_ffn__decode'

def setup_inputs():

    _w = (lambda a: (lambda t: t.to(torch.bfloat16) if t.is_floating_point() else t)(torch.as_tensor(a)))
    def _A_setup():
        B, Sq, D = 2, 1, 640
        H, Sk, Dh = 32, 4096, 192
        return {
            "x": _w((lambda *s: torch.randn(*s, dtype=torch.bfloat16) * 0.05)(B, Sq, D)),
            "k_cache": _w((lambda *s: torch.randn(*s, dtype=torch.bfloat16) * 1.6)(B, H, Sk, Dh)),
            "v_cache": _w((lambda *s: torch.randn(*s, dtype=torch.bfloat16) * 0.2)(B, H, Sk, Dh)),
            "wq": _w((lambda *s: torch.randn(*s, dtype=torch.bfloat16) * 1.6)(D, H * Dh) * (D ** -0.5)),
            "wo": _w((lambda *s: torch.randn(*s, dtype=torch.bfloat16) * 0.2)(H * Dh, D) * ((H * Dh) ** -0.5)),
        }
    _A_in = _A_setup()

    def _B_setup():
        B, S, D, F = 2, 1, 640, 1536
        return {
            "x": _w((lambda *s: torch.randn(*s, dtype=torch.bfloat16) * 0.05)(B, S, D)),
            "w_gate": _w((lambda *s: torch.randn(*s, dtype=torch.bfloat16) * 0.1)(D, F)),
            "w_up": _w((lambda *s: torch.randn(*s, dtype=torch.bfloat16) * 0.1)(D, F)),
            "w_down": _w((lambda *s: torch.randn(*s, dtype=torch.bfloat16) * 0.1)(F, D)),
        }
    _B_in = _B_setup()

    return {
        "A_x": _A_in["x"],
        "A_k_cache": _A_in["k_cache"],
        "A_v_cache": _A_in["v_cache"],
        "A_wq": _A_in["wq"],
        "A_wo": _A_in["wo"],
        "B_x": _B_in["x"],
        "B_w_gate": _B_in["w_gate"],
        "B_w_up": _B_in["w_up"],
        "B_w_down": _B_in["w_down"],
    }

def reference(A_x, A_k_cache, A_v_cache, A_wq, A_wo, B_x, B_w_gate, B_w_up, B_w_down):
    def _A_ref(x, k_cache, v_cache, wq, wo):
        B, Sq, D = x.shape
        H, Dh = 32, 192
        q = (lambda x, *d: x.permute(*d))((x @ wq).reshape(B, Sq, H, Dh), 0, 2, 1, 3)
        scores = torch.einsum("bhqd,bhkd->bhqk", q, k_cache) * (Dh ** -0.5)
        p = _softmax(scores, axis=-1)
        o = torch.einsum("bhqk,bhkd->bhqd", p, v_cache)
        return (lambda x, *d: x.permute(*d))(o, 0, 2, 1, 3).reshape(B, Sq, H * Dh) @ wo

    def _B_ref(x, w_gate, w_up, w_down):
        return (_gelu(x @ w_gate) * (x @ w_up)) @ w_down

    x = A_x
    xn = _layernorm(x, axis=-1)
    s = _A_ref(xn, A_k_cache, A_v_cache, A_wq, A_wo)
    g = _silu(_B_ref(xn, B_w_gate, B_w_up, B_w_down))
    return x + s * g
```

```asm
; @launch grid=(280,1,1) block=(256,1,1) lds=69120
.amdgcn_target "amdgcn-amd-amdhsa--gfx950"
.text
.globl recurrent_scan__mha_block_cached__geglu_ffn__decode_kernel
.p2align 8
.type recurrent_scan__mha_block_cached__geglu_ffn__decode_kernel,@function
recurrent_scan__mha_block_cached__geglu_ffn__decode_kernel:
s_cmp_ge_u32 s2, 280
s_cbranch_scc1 L_end
s_load_dwordx8 s[4:11], s[0:1], 0
s_load_dwordx2 s[12:13], s[0:1], 32
s_load_dwordx4 s[24:27], s[0:1], 80
s_load_dwordx4 s[16:19], s[0:1], 48
s_load_dwordx4 s[20:23], s[0:1], 64
v_and_b32 v1, 63, v0
v_lshrrev_b32 v2, 6, v0
s_nop 0
v_readfirstlane_b32 s56, v2
s_and_b32 s58, s2, 7
s_lshr_b32 s57, s2, 3
s_lshl_b32 s63, s58, 2
s_add_u32 s57, s57, s63
s_and_b32 s57, s57, 31
s_lshr_b32 s63, s57, 2
s_sub_u32 s58, s58, s63
s_add_u32 s58, s58, 7
s_and_b32 s58, s58, 7
s_lshr_b32 s94, s2, 3
s_sub_u32 s94, s94, 3
s_mul_i32 s95, s94, 43
s_lshr_b32 s95, s95, 8
s_and_b32 s96, s2, 7
s_lshl_b32 s96, s96, 2
s_add_u32 s96, s96, s95
s_mul_i32 s95, s95, 6
s_sub_u32 s95, s94, s95
s_cmp_ge_u32 s95, 3
s_cselect_b32 s15, 1, 0
s_mul_i32 s14, s15, 3
s_sub_u32 s14, s95, s14
s_mov_b32 s46, 2560
s_mov_b32 s47, 0x20000
s_mov_b32 s42, 4194304
s_mov_b32 s43, 0x20000
s_mov_b32 s50, 2560
s_mov_b32 s51, 0x20000
v_mul_u32_u24 v4, 20, v1
s_waitcnt lgkmcnt(0)
s_mov_b32 s44, s4
s_mov_b32 s45, s5
s_load_dword s61, s[26:27], 0
s_mov_b32 s40, s26
s_mov_b32 s41, s27
s_mov_b32 s48, s22
s_mov_b32 s49, s23
s_cmp_ge_u32 s2, 256
s_cbranch_scc1 L_ffn
s_cmp_ge_u32 s94, 24
s_cbranch_scc1 L_setup
v_mul_u32_u24 v4, 20, v1
buffer_load_dwordx4 v[8:11], v4, s[44:47], 0 offen
buffer_load_dword v12, v4, s[44:47], 0 offen offset:16
buffer_load_dwordx4 v[14:17], v4, s[44:47], 0 offen offset:1280
buffer_load_dword v18, v4, s[44:47], 0 offen offset:1296
s_mul_i32 s62, s96, 384
s_lshl_b32 s63, s14, 7
s_add_u32 s62, s62, s63
s_mul_i32 s63, s15, 3932160
s_add_u32 s62, s62, s63
s_add_u32 s36, s10, s62
s_addc_u32 s37, s11, 0
s_mov_b32 s38, 3920000
s_mov_b32 s39, 0x20000
v_lshrrev_b32 v6, 3, v1
v_mul_u32_u24 v6, 40, v6
s_mul_i32 s62, s56, 10
v_add_u32 v6, s62, v6
s_mov_b32 s62, 12288
v_mul_lo_u32 v6, v6, s62
v_and_b32 v7, 7, v1
v_lshl_add_u32 v4, v7, 4, v6
s_mov_b32 s63, 0
buffer_load_dwordx4 v[156:159], v4, s[36:39], s63 offen nt
s_add_u32 s63, s63, 12288
buffer_load_dwordx4 v[160:163], v4, s[36:39], s63 offen nt
s_add_u32 s63, s63, 12288
buffer_load_dwordx4 v[164:167], v4, s[36:39], s63 offen nt
s_add_u32 s63, s63, 12288
buffer_load_dwordx4 v[168:171], v4, s[36:39], s63 offen nt
s_add_u32 s63, s63, 12288
buffer_load_dwordx4 v[172:175], v4, s[36:39], s63 offen nt
s_add_u32 s63, s63, 12288
buffer_load_dwordx4 v[176:179], v4, s[36:39], s63 offen nt
s_add_u32 s63, s63, 12288
buffer_load_dwordx4 v[180:183], v4, s[36:39], s63 offen nt
s_add_u32 s63, s63, 12288
buffer_load_dwordx4 v[184:187], v4, s[36:39], s63 offen nt
s_add_u32 s63, s63, 12288
buffer_load_dwordx4 v[188:191], v4, s[36:39], s63 offen nt
s_add_u32 s63, s63, 12288
buffer_load_dwordx4 v[192:195], v4, s[36:39], s63 offen nt
L_setup:
s_mul_i32 s93, s57, 112
s_mul_i32 s63, s57, 1572864
s_add_u32 s28, s6, s63
s_addc_u32 s29, s7, 0
s_mov_b32 s31, 0x20000
s_add_u32 s32, s8, s63
s_addc_u32 s33, s9, 0
s_mov_b32 s35, 0x20000
s_mov_b32 s30, 51904512
s_mov_b32 s34, 51904512
s_lshl_b32 s63, s57, 8
s_add_u32 s63, s63, 4096
s_add_u32 s88, s26, s63
s_addc_u32 s89, s27, 0
v_lshrrev_b32 v6, 3, v1
v_mul_u32_u24 v3, 384, v6
v_and_b32 v7, 7, v1
v_lshl_add_u32 v3, v7, 4, v3
s_lshl_b32 s62, s58, 2
s_add_u32 s62, s62, s56
s_mul_i32 s62, s62, 6
s_add_u32 s80, s62, 0
s_add_u32 s81, s62, 1
s_add_u32 s82, s62, 2
s_add_u32 s83, s62, 3
s_add_u32 s84, s62, 4
s_add_u32 s85, s62, 5
s_or_b32 s62, s95, s56
s_cmp_lg_u32 s62, 0
s_cbranch_scc1 L_noinit
s_cmp_ge_u32 s94, 24
s_cbranch_scc1 L_noinit
s_lshl_b32 s63, s96, 8
s_add_u32 s63, s63, 4096
s_add_u32 s16, s26, s63
s_addc_u32 s17, s27, 0
s_mov_b32 s86, 192
s_atomic_swap s86, s[16:17], 0 glc
L_noinit:
s_cmp_ge_u32 s94, 24
s_cbranch_scc1 L_nowq
s_waitcnt vmcnt(10)
v_lshlrev_b32 v20, 16, v8
v_and_b32 v21, 0xffff0000, v8
v_lshlrev_b32 v22, 16, v9
v_and_b32 v23, 0xffff0000, v9
v_lshlrev_b32 v24, 16, v10
v_and_b32 v25, 0xffff0000, v10
v_lshlrev_b32 v26, 16, v11
v_and_b32 v27, 0xffff0000, v11
v_lshlrev_b32 v28, 16, v12
v_and_b32 v29, 0xffff0000, v12
v_lshlrev_b32 v30, 16, v14
v_and_b32 v31, 0xffff0000, v14
v_lshlrev_b32 v32, 16, v15
v_and_b32 v33, 0xffff0000, v15
v_lshlrev_b32 v34, 16, v16
v_and_b32 v35, 0xffff0000, v16
v_lshlrev_b32 v36, 16, v17
v_and_b32 v37, 0xffff0000, v17
v_lshlrev_b32 v38, 16, v18
v_and_b32 v39, 0xffff0000, v18
v_add_f32 v40, v20, v21
v_add_f32 v41, v30, v31
v_add_f32 v40, v40, v22
v_add_f32 v41, v41, v32
v_add_f32 v40, v40, v23
v_add_f32 v41, v41, v33
v_add_f32 v40, v40, v24
v_add_f32 v41, v41, v34
v_add_f32 v40, v40, v25
v_add_f32 v41, v41, v35
v_add_f32 v40, v40, v26
v_add_f32 v41, v41, v36
v_add_f32 v40, v40, v27
v_add_f32 v41, v41, v37
v_add_f32 v40, v40, v28
v_add_f32 v41, v41, v38
v_add_f32 v40, v40, v29
v_add_f32 v41, v41, v39
s_nop 0
v_add_f32_dpp v40, v40, v40 quad_perm:[1,0,3,2] row_mask:0xf bank_mask:0xf
v_add_f32_dpp v41, v41, v41 quad_perm:[1,0,3,2] row_mask:0xf bank_mask:0xf
s_nop 0
v_add_f32_dpp v40, v40, v40 quad_perm:[2,3,0,1] row_mask:0xf bank_mask:0xf
v_add_f32_dpp v41, v41, v41 quad_perm:[2,3,0,1] row_mask:0xf bank_mask:0xf
s_nop 0
v_add_f32_dpp v40, v40, v40 row_half_mirror row_mask:0xf bank_mask:0xf
v_add_f32_dpp v41, v41, v41 row_half_mirror row_mask:0xf bank_mask:0xf
s_nop 0
v_add_f32_dpp v40, v40, v40 row_mirror row_mask:0xf bank_mask:0xf
v_add_f32_dpp v41, v41, v41 row_mirror row_mask:0xf bank_mask:0xf
v_mov_b32 v46, v40
v_mov_b32 v47, v41
s_nop 0
v_permlane16_swap_b32 v40, v46
v_permlane16_swap_b32 v41, v47
v_add_f32 v40, v40, v46
v_add_f32 v41, v41, v47
v_mov_b32 v46, v40
v_mov_b32 v47, v41
s_nop 0
v_permlane32_swap_b32 v40, v46
v_permlane32_swap_b32 v41, v47
v_add_f32 v40, v40, v46
v_add_f32 v41, v41, v47
s_mov_b32 s62, 0x3acccccd
v_mul_f32 v40, s62, v40
v_mul_f32 v41, s62, v41
v_sub_f32 v48, v20, v40
v_sub_f32 v49, v30, v41
v_mul_f32 v42, v48, v48
v_mul_f32 v43, v49, v49
v_sub_f32 v50, v21, v40
v_sub_f32 v51, v31, v41
v_fmac_f32 v42, v50, v50
v_fmac_f32 v43, v51, v51
v_sub_f32 v48, v22, v40
v_sub_f32 v49, v32, v41
v_fmac_f32 v42, v48, v48
v_fmac_f32 v43, v49, v49
v_sub_f32 v50, v23, v40
v_sub_f32 v51, v33, v41
v_fmac_f32 v42, v50, v50
v_fmac_f32 v43, v51, v51
v_sub_f32 v48, v24, v40
v_sub_f32 v49, v34, v41
v_fmac_f32 v42, v48, v48
v_fmac_f32 v43, v49, v49
v_sub_f32 v50, v25, v40
v_sub_f32 v51, v35, v41
v_fmac_f32 v42, v50, v50
v_fmac_f32 v43, v51, v51
v_sub_f32 v48, v26, v40
v_sub_f32 v49, v36, v41
v_fmac_f32 v42, v48, v48
v_fmac_f32 v43, v49, v49
v_sub_f32 v50, v27, v40
v_sub_f32 v51, v37, v41
v_fmac_f32 v42, v50, v50
v_fmac_f32 v43, v51, v51
v_sub_f32 v48, v28, v40
v_sub_f32 v49, v38, v41
v_fmac_f32 v42, v48, v48
v_fmac_f32 v43, v49, v49
v_sub_f32 v50, v29, v40
v_sub_f32 v51, v39, v41
v_fmac_f32 v42, v50, v50
v_fmac_f32 v43, v51, v51
s_nop 0
v_add_f32_dpp v42, v42, v42 quad_perm:[1,0,3,2] row_mask:0xf bank_mask:0xf
v_add_f32_dpp v43, v43, v43 quad_perm:[1,0,3,2] row_mask:0xf bank_mask:0xf
s_nop 0
v_add_f32_dpp v42, v42, v42 quad_perm:[2,3,0,1] row_mask:0xf bank_mask:0xf
v_add_f32_dpp v43, v43, v43 quad_perm:[2,3,0,1] row_mask:0xf bank_mask:0xf
s_nop 0
v_add_f32_dpp v42, v42, v42 row_half_mirror row_mask:0xf bank_mask:0xf
v_add_f32_dpp v43, v43, v43 row_half_mirror row_mask:0xf bank_mask:0xf
s_nop 0
v_add_f32_dpp v42, v42, v42 row_mirror row_mask:0xf bank_mask:0xf
v_add_f32_dpp v43, v43, v43 row_mirror row_mask:0xf bank_mask:0xf
v_mov_b32 v46, v42
v_mov_b32 v47, v43
s_nop 0
v_permlane16_swap_b32 v42, v46
v_permlane16_swap_b32 v43, v47
v_add_f32 v42, v42, v46
v_add_f32 v43, v43, v47
v_mov_b32 v46, v42
v_mov_b32 v47, v43
s_nop 0
v_permlane32_swap_b32 v42, v46
v_permlane32_swap_b32 v43, v47
v_add_f32 v42, v42, v46
v_add_f32 v43, v43, v47
v_mul_f32 v42, s62, v42
v_mul_f32 v43, s62, v43
v_cvt_pk_bf16_f32 v46, v40, v41
v_cvt_pk_bf16_f32 v47, v42, v43
v_lshlrev_b32 v40, 16, v46
v_and_b32 v41, 0xffff0000, v46
v_lshlrev_b32 v42, 16, v47
v_and_b32 v43, 0xffff0000, v47
v_add_f32 v42, 0x3727c5ac, v42
v_add_f32 v43, 0x3727c5ac, v43
v_cvt_pk_bf16_f32 v46, v42, v43
v_lshlrev_b32 v42, 16, v46
v_and_b32 v43, 0xffff0000, v46
v_sqrt_f32 v42, v42
v_sqrt_f32 v43, v43
s_nop 0
v_cvt_pk_bf16_f32 v46, v42, v43
v_lshlrev_b32 v42, 16, v46
v_and_b32 v43, 0xffff0000, v46
v_rcp_f32 v42, v42
v_rcp_f32 v43, v43
v_mul_u32_u24 v5, 20, v1
v_sub_f32 v20, v20, v40
v_sub_f32 v21, v21, v40
v_sub_f32 v30, v30, v41
v_sub_f32 v31, v31, v41
v_cvt_pk_bf16_f32 v46, v20, v21
v_cvt_pk_bf16_f32 v47, v30, v31
v_lshlrev_b32 v20, 16, v46
v_and_b32 v21, 0xffff0000, v46
v_lshlrev_b32 v30, 16, v47
v_and_b32 v31, 0xffff0000, v47
v_mul_f32 v20, v20, v42
v_mul_f32 v21, v21, v42
v_mul_f32 v30, v30, v43
v_mul_f32 v31, v31, v43
v_cvt_pk_bf16_f32 v20, v20, v21
v_cvt_pk_bf16_f32 v30, v30, v31
ds_write_b32 v5, v20 offset:0
ds_write_b32 v5, v30 offset:1280
v_sub_f32 v22, v22, v40
v_sub_f32 v23, v23, v40
v_sub_f32 v32, v32, v41
v_sub_f32 v33, v33, v41
v_cvt_pk_bf16_f32 v46, v22, v23
v_cvt_pk_bf16_f32 v47, v32, v33
v_lshlrev_b32 v22, 16, v46
v_and_b32 v23, 0xffff0000, v46
v_lshlrev_b32 v32, 16, v47
v_and_b32 v33, 0xffff0000, v47
v_mul_f32 v22, v22, v42
v_mul_f32 v23, v23, v42
v_mul_f32 v32, v32, v43
v_mul_f32 v33, v33, v43
v_cvt_pk_bf16_f32 v22, v22, v23
v_cvt_pk_bf16_f32 v32, v32, v33
ds_write_b32 v5, v22 offset:4
ds_write_b32 v5, v32 offset:1284
v_sub_f32 v24, v24, v40
v_sub_f32 v25, v25, v40
v_sub_f32 v34, v34, v41
v_sub_f32 v35, v35, v41
v_cvt_pk_bf16_f32 v46, v24, v25
v_cvt_pk_bf16_f32 v47, v34, v35
v_lshlrev_b32 v24, 16, v46
v_and_b32 v25, 0xffff0000, v46
v_lshlrev_b32 v34, 16, v47
v_and_b32 v35, 0xffff0000, v47
v_mul_f32 v24, v24, v42
v_mul_f32 v25, v25, v42
v_mul_f32 v34, v34, v43
v_mul_f32 v35, v35, v43
v_cvt_pk_bf16_f32 v24, v24, v25
v_cvt_pk_bf16_f32 v34, v34, v35
ds_write_b32 v5, v24 offset:8
ds_write_b32 v5, v34 offset:1288
v_sub_f32 v26, v26, v40
v_sub_f32 v27, v27, v40
v_sub_f32 v36, v36, v41
v_sub_f32 v37, v37, v41
v_cvt_pk_bf16_f32 v46, v26, v27
v_cvt_pk_bf16_f32 v47, v36, v37
v_lshlrev_b32 v26, 16, v46
v_and_b32 v27, 0xffff0000, v46
v_lshlrev_b32 v36, 16, v47
v_and_b32 v37, 0xffff0000, v47
v_mul_f32 v26, v26, v42
v_mul_f32 v27, v27, v42
v_mul_f32 v36, v36, v43
v_mul_f32 v37, v37, v43
v_cvt_pk_bf16_f32 v26, v26, v27
v_cvt_pk_bf16_f32 v36, v36, v37
ds_write_b32 v5, v26 offset:12
ds_write_b32 v5, v36 offset:1292
v_sub_f32 v28, v28, v40
v_sub_f32 v29, v29, v40
v_sub_f32 v38, v38, v41
v_sub_f32 v39, v39, v41
v_cvt_pk_bf16_f32 v46, v28, v29
v_cvt_pk_bf16_f32 v47, v38, v39
v_lshlrev_b32 v28, 16, v46
v_and_b32 v29, 0xffff0000, v46
v_lshlrev_b32 v38, 16, v47
v_and_b32 v39, 0xffff0000, v47
v_mul_f32 v28, v28, v42
v_mul_f32 v29, v29, v42
v_mul_f32 v38, v38, v43
v_mul_f32 v39, v39, v43
v_cvt_pk_bf16_f32 v28, v28, v29
v_cvt_pk_bf16_f32 v38, v38, v39
ds_write_b32 v5, v28 offset:16
ds_write_b32 v5, v38 offset:1296
s_mul_i32 s63, s15, 640
v_lshrrev_b32 v6, 3, v1
v_mul_u32_u24 v6, 80, v6
s_mul_i32 s62, s56, 20
s_add_u32 s62, s62, s63
v_add_u32 v6, s62, v6
s_waitcnt lgkmcnt(0)
ds_read_b32 v236, v6 offset:0
ds_read_b32 v237, v6 offset:4
ds_read_b32 v238, v6 offset:8
ds_read_b32 v239, v6 offset:12
ds_read_b32 v240, v6 offset:16
ds_read_b32 v246, v6 offset:1280
ds_read_b32 v247, v6 offset:1284
ds_read_b32 v248, v6 offset:1288
ds_read_b32 v249, v6 offset:1292
ds_read_b32 v250, v6 offset:1296
s_lshr_b32 s62, s80, 9
s_mul_i32 s62, s62, 50331648
s_add_u32 s63, s80, s93
s_and_b32 s63, s63, 511
s_mul_i32 s63, s63, 3072
s_add_u32 s62, s62, s63
s_cmp_ge_u32 s80, 1024
s_cselect_b32 s62, 0xf0000000, s62
v_add_u32 v2, s62, v3
buffer_load_dwordx4 v[60:63], v2, s[28:31], 0 offen offset:0 nt
buffer_load_dwordx4 v[64:67], v2, s[28:31], 0 offen offset:128 nt
buffer_load_dwordx4 v[68:71], v2, s[28:31], 0 offen offset:256 nt
buffer_load_dwordx4 v[72:75], v2, s[32:35], 0 offen offset:0 nt
buffer_load_dwordx4 v[76:79], v2, s[32:35], 0 offen offset:128 nt
buffer_load_dwordx4 v[80:83], v2, s[32:35], 0 offen offset:256 nt
v_mov_b32 v20, 0
v_mov_b32 v21, 0
v_mov_b32 v22, 0
v_mov_b32 v23, 0
v_mov_b32 v24, 0
v_mov_b32 v25, 0
v_mov_b32 v26, 0
v_mov_b32 v27, 0
v_mov_b32 v28, 0
v_mov_b32 v29, 0
v_mov_b32 v30, 0
v_mov_b32 v31, 0
v_mov_b32 v32, 0
v_mov_b32 v33, 0
v_mov_b32 v34, 0
v_mov_b32 v35, 0
s_waitcnt lgkmcnt(0)
s_waitcnt vmcnt(15)
v_and_b32 v52, 0xffff, v236
v_lshlrev_b32 v53, 16, v236
v_and_b32 v54, 0xffff, v246
v_lshlrev_b32 v55, 16, v246
v_dot2c_f32_bf16 v20, v156, v52
v_dot2c_f32_bf16 v21, v156, v53
v_dot2c_f32_bf16 v28, v156, v54
v_dot2c_f32_bf16 v29, v156, v55
v_dot2c_f32_bf16 v22, v157, v52
v_dot2c_f32_bf16 v23, v157, v53
v_dot2c_f32_bf16 v30, v157, v54
v_dot2c_f32_bf16 v31, v157, v55
v_dot2c_f32_bf16 v24, v158, v52
v_dot2c_f32_bf16 v25, v158, v53
v_dot2c_f32_bf16 v32, v158, v54
v_dot2c_f32_bf16 v33, v158, v55
v_dot2c_f32_bf16 v26, v159, v52
v_dot2c_f32_bf16 v27, v159, v53
v_dot2c_f32_bf16 v34, v159, v54
v_dot2c_f32_bf16 v35, v159, v55
s_waitcnt vmcnt(14)
v_lshrrev_b32 v52, 16, v236
v_and_b32 v53, 0xffff0000, v236
v_lshrrev_b32 v54, 16, v246
v_and_b32 v55, 0xffff0000, v246
v_dot2c_f32_bf16 v20, v160, v52
v_dot2c_f32_bf16 v21, v160, v53
v_dot2c_f32_bf16 v28, v160, v54
v_dot2c_f32_bf16 v29, v160, v55
v_dot2c_f32_bf16 v22, v161, v52
v_dot2c_f32_bf16 v23, v161, v53
v_dot2c_f32_bf16 v30, v161, v54
v_dot2c_f32_bf16 v31, v161, v55
v_dot2c_f32_bf16 v24, v162, v52
v_dot2c_f32_bf16 v25, v162, v53
v_dot2c_f32_bf16 v32, v162, v54
v_dot2c_f32_bf16 v33, v162, v55
v_dot2c_f32_bf16 v26, v163, v52
v_dot2c_f32_bf16 v27, v163, v53
v_dot2c_f32_bf16 v34, v163, v54
v_dot2c_f32_bf16 v35, v163, v55
s_waitcnt vmcnt(13)
v_and_b32 v52, 0xffff, v237
v_lshlrev_b32 v53, 16, v237
v_and_b32 v54, 0xffff, v247
v_lshlrev_b32 v55, 16, v247
v_dot2c_f32_bf16 v20, v164, v52
v_dot2c_f32_bf16 v21, v164, v53
v_dot2c_f32_bf16 v28, v164, v54
v_dot2c_f32_bf16 v29, v164, v55
v_dot2c_f32_bf16 v22, v165, v52
v_dot2c_f32_bf16 v23, v165, v53
v_dot2c_f32_bf16 v30, v165, v54
v_dot2c_f32_bf16 v31, v165, v55
v_dot2c_f32_bf16 v24, v166, v52
v_dot2c_f32_bf16 v25, v166, v53
v_dot2c_f32_bf16 v32, v166, v54
v_dot2c_f32_bf16 v33, v166, v55
v_dot2c_f32_bf16 v26, v167, v52
v_dot2c_f32_bf16 v27, v167, v53
v_dot2c_f32_bf16 v34, v167, v54
v_dot2c_f32_bf16 v35, v167, v55
s_waitcnt vmcnt(12)
v_lshrrev_b32 v52, 16, v237
v_and_b32 v53, 0xffff0000, v237
v_lshrrev_b32 v54, 16, v247
v_and_b32 v55, 0xffff0000, v247
v_dot2c_f32_bf16 v20, v168, v52
v_dot2c_f32_bf16 v21, v168, v53
v_dot2c_f32_bf16 v28, v168, v54
v_dot2c_f32_bf16 v29, v168, v55
v_dot2c_f32_bf16 v22, v169, v52
v_dot2c_f32_bf16 v23, v169, v53
v_dot2c_f32_bf16 v30, v169, v54
v_dot2c_f32_bf16 v31, v169, v55
v_dot2c_f32_bf16 v24, v170, v52
v_dot2c_f32_bf16 v25, v170, v53
v_dot2c_f32_bf16 v32, v170, v54
v_dot2c_f32_bf16 v33, v170, v55
v_dot2c_f32_bf16 v26, v171, v52
v_dot2c_f32_bf16 v27, v171, v53
v_dot2c_f32_bf16 v34, v171, v54
v_dot2c_f32_bf16 v35, v171, v55
s_waitcnt vmcnt(11)
v_and_b32 v52, 0xffff, v238
v_lshlrev_b32 v53, 16, v238
v_and_b32 v54, 0xffff, v248
v_lshlrev_b32 v55, 16, v248
v_dot2c_f32_bf16 v20, v172, v52
v_dot2c_f32_bf16 v21, v172, v53
v_dot2c_f32_bf16 v28, v172, v54
v_dot2c_f32_bf16 v29, v172, v55
v_dot2c_f32_bf16 v22, v173, v52
v_dot2c_f32_bf16 v23, v173, v53
v_dot2c_f32_bf16 v30, v173, v54
v_dot2c_f32_bf16 v31, v173, v55
v_dot2c_f32_bf16 v24, v174, v52
v_dot2c_f32_bf16 v25, v174, v53
v_dot2c_f32_bf16 v32, v174, v54
v_dot2c_f32_bf16 v33, v174, v55
v_dot2c_f32_bf16 v26, v175, v52
v_dot2c_f32_bf16 v27, v175, v53
v_dot2c_f32_bf16 v34, v175, v54
v_dot2c_f32_bf16 v35, v175, v55
s_waitcnt vmcnt(10)
v_lshrrev_b32 v52, 16, v238
v_and_b32 v53, 0xffff0000, v238
v_lshrrev_b32 v54, 16, v248
v_and_b32 v55, 0xffff0000, v248
v_dot2c_f32_bf16 v20, v176, v52
v_dot2c_f32_bf16 v21, v176, v53
v_dot2c_f32_bf16 v28, v176, v54
v_dot2c_f32_bf16 v29, v176, v55
v_dot2c_f32_bf16 v22, v177, v52
v_dot2c_f32_bf16 v23, v177, v53
v_dot2c_f32_bf16 v30, v177, v54
v_dot2c_f32_bf16 v31, v177, v55
v_dot2c_f32_bf16 v24, v178, v52
v_dot2c_f32_bf16 v25, v178, v53
v_dot2c_f32_bf16 v32, v178, v54
v_dot2c_f32_bf16 v33, v178, v55
v_dot2c_f32_bf16 v26, v179, v52
v_dot2c_f32_bf16 v27, v179, v53
v_dot2c_f32_bf16 v34, v179, v54
v_dot2c_f32_bf16 v35, v179, v55
s_waitcnt vmcnt(9)
v_and_b32 v52, 0xffff, v239
v_lshlrev_b32 v53, 16, v239
v_and_b32 v54, 0xffff, v249
v_lshlrev_b32 v55, 16, v249
v_dot2c_f32_bf16 v20, v180, v52
v_dot2c_f32_bf16 v21, v180, v53
v_dot2c_f32_bf16 v28, v180, v54
v_dot2c_f32_bf16 v29, v180, v55
v_dot2c_f32_bf16 v22, v181, v52
v_dot2c_f32_bf16 v23, v181, v53
v_dot2c_f32_bf16 v30, v181, v54
v_dot2c_f32_bf16 v31, v181, v55
v_dot2c_f32_bf16 v24, v182, v52
v_dot2c_f32_bf16 v25, v182, v53
v_dot2c_f32_bf16 v32, v182, v54
v_dot2c_f32_bf16 v33, v182, v55
v_dot2c_f32_bf16 v26, v183, v52
v_dot2c_f32_bf16 v27, v183, v53
v_dot2c_f32_bf16 v34, v183, v54
v_dot2c_f32_bf16 v35, v183, v55
s_waitcnt vmcnt(8)
v_lshrrev_b32 v52, 16, v239
v_and_b32 v53, 0xffff0000, v239
v_lshrrev_b32 v54, 16, v249
v_and_b32 v55, 0xffff0000, v249
v_dot2c_f32_bf16 v20, v184, v52
v_dot2c_f32_bf16 v21, v184, v53
v_dot2c_f32_bf16 v28, v184, v54
v_dot2c_f32_bf16 v29, v184, v55
v_dot2c_f32_bf16 v22, v185, v52
v_dot2c_f32_bf16 v23, v185, v53
v_dot2c_f32_bf16 v30, v185, v54
v_dot2c_f32_bf16 v31, v185, v55
v_dot2c_f32_bf16 v24, v186, v52
v_dot2c_f32_bf16 v25, v186, v53
v_dot2c_f32_bf16 v32, v186, v54
v_dot2c_f32_bf16 v33, v186, v55
v_dot2c_f32_bf16 v26, v187, v52
v_dot2c_f32_bf16 v27, v187, v53
v_dot2c_f32_bf16 v34, v187, v54
v_dot2c_f32_bf16 v35, v187, v55
s_waitcnt vmcnt(7)
v_and_b32 v52, 0xffff, v240
v_lshlrev_b32 v53, 16, v240
v_and_b32 v54, 0xffff, v250
v_lshlrev_b32 v55, 16, v250
v_dot2c_f32_bf16 v20, v188, v52
v_dot2c_f32_bf16 v21, v188, v53
v_dot2c_f32_bf16 v28, v188, v54
v_dot2c_f32_bf16 v29, v188, v55
v_dot2c_f32_bf16 v22, v189, v52
v_dot2c_f32_bf16 v23, v189, v53
v_dot2c_f32_bf16 v30, v189, v54
v_dot2c_f32_bf16 v31, v189, v55
v_dot2c_f32_bf16 v24, v190, v52
v_dot2c_f32_bf16 v25, v190, v53
v_dot2c_f32_bf16 v32, v190, v54
v_dot2c_f32_bf16 v33, v190, v55
v_dot2c_f32_bf16 v26, v191, v52
v_dot2c_f32_bf16 v27, v191, v53
v_dot2c_f32_bf16 v34, v191, v54
v_dot2c_f32_bf16 v35, v191, v55
s_waitcnt vmcnt(6)
v_lshrrev_b32 v52, 16, v240
v_and_b32 v53, 0xffff0000, v240
v_lshrrev_b32 v54, 16, v250
v_and_b32 v55, 0xffff0000, v250
v_dot2c_f32_bf16 v20, v192, v52
v_dot2c_f32_bf16 v21, v192, v53
v_dot2c_f32_bf16 v28, v192, v54
v_dot2c_f32_bf16 v29, v192, v55
v_dot2c_f32_bf16 v22, v193, v52
v_dot2c_f32_bf16 v23, v193, v53
v_dot2c_f32_bf16 v30, v193, v54
v_dot2c_f32_bf16 v31, v193, v55
v_dot2c_f32_bf16 v24, v194, v52
v_dot2c_f32_bf16 v25, v194, v53
v_dot2c_f32_bf16 v32, v194, v54
v_dot2c_f32_bf16 v33, v194, v55
v_dot2c_f32_bf16 v26, v195, v52
v_dot2c_f32_bf16 v27, v195, v53
v_dot2c_f32_bf16 v34, v195, v54
v_dot2c_f32_bf16 v35, v195, v55
v_permlane32_swap_b32 v20, v28
v_permlane32_swap_b32 v21, v29
v_permlane32_swap_b32 v22, v30
v_permlane32_swap_b32 v23, v31
v_permlane32_swap_b32 v24, v32
v_permlane32_swap_b32 v25, v33
v_permlane32_swap_b32 v26, v34
v_permlane32_swap_b32 v27, v35
v_add_f32 v20, v20, v28
v_add_f32 v21, v21, v29
v_add_f32 v22, v22, v30
v_add_f32 v23, v23, v31
v_add_f32 v24, v24, v32
v_add_f32 v25, v25, v33
v_add_f32 v26, v26, v34
v_add_f32 v27, v27, v35
v_permlane16_swap_b32 v20, v24
v_permlane16_swap_b32 v21, v25
v_permlane16_swap_b32 v22, v26
v_permlane16_swap_b32 v23, v27
v_add_f32 v20, v20, v24
v_add_f32 v21, v21, v25
v_add_f32 v22, v22, v26
v_add_f32 v23, v23, v27
v_add_f32_dpp v20, v20, v20 row_ror:8 row_mask:0xf bank_mask:0xf
v_add_f32_dpp v21, v21, v21 row_ror:8 row_mask:0xf bank_mask:0xf
v_add_f32_dpp v22, v22, v22 row_ror:8 row_mask:0xf bank_mask:0xf
v_add_f32_dpp v23, v23, v23 row_ror:8 row_mask:0xf bank_mask:0xf
v_lshrrev_b32 v6, 5, v1
v_lshlrev_b32 v6, 8, v6
v_and_b32 v7, 7, v1
v_lshl_add_u32 v6, v7, 5, v6
v_bfe_u32 v7, v1, 4, 1
v_lshl_add_u32 v6, v7, 4, v6
s_lshl_b32 s62, s56, 9
v_add_u32 v6, s62, v6
ds_write_b128 v6, v[20:23] offset:2560
s_waitcnt lgkmcnt(0)
s_barrier
s_cmp_lg_u32 s56, 0
s_cbranch_scc1 L_kvrest0
v_lshlrev_b32 v6, 3, v1
ds_read_b64 v[20:21], v6 offset:2560
ds_read_b64 v[22:23], v6 offset:3072
ds_read_b64 v[24:25], v6 offset:3584
ds_read_b64 v[26:27], v6 offset:4096
s_mul_i32 s60, s61, 0x9E3779B1
s_add_u32 s60, s60, 0x7F4A7C15
v_lshrrev_b32 v6, 5, v1
v_mul_u32_u24 v6, 3072, v6
v_and_b32 v7, 31, v1
v_lshl_add_u32 v6, v7, 5, v6
s_lshl_b32 s62, s96, 13
s_lshl_b32 s63, s14, 10
s_add_u32 s62, s62, s63
s_lshl_b32 s63, s15, 4
s_add_u32 s62, s62, s63
s_add_u32 s62, s62, 16384
s_waitcnt lgkmcnt(0)
v_add_f32 v20, v20, v22
v_add_f32 v21, v21, v23
v_add_f32 v24, v24, v26
v_add_f32 v25, v25, v27
v_add_f32 v40, v20, v24
v_add_f32 v42, v21, v25
v_mov_b32 v41, s60
v_mov_b32 v43, s60
buffer_store_dwordx4 v[40:43], v6, s[40:43], s62 offen sc0 sc1
s_barrier
s_branch L_kvrest
L_kvrest0:
s_barrier
s_branch L_kvrest
L_nowq:
s_lshr_b32 s62, s80, 9
s_mul_i32 s62, s62, 50331648
s_add_u32 s63, s80, s93
s_and_b32 s63, s63, 511
s_mul_i32 s63, s63, 3072
s_add_u32 s62, s62, s63
s_cmp_ge_u32 s80, 1024
s_cselect_b32 s62, 0xf0000000, s62
v_add_u32 v2, s62, v3
buffer_load_dwordx4 v[60:63], v2, s[28:31], 0 offen offset:0 nt
buffer_load_dwordx4 v[64:67], v2, s[28:31], 0 offen offset:128 nt
buffer_load_dwordx4 v[68:71], v2, s[28:31], 0 offen offset:256 nt
buffer_load_dwordx4 v[72:75], v2, s[32:35], 0 offen offset:0 nt
buffer_load_dwordx4 v[76:79], v2, s[32:35], 0 offen offset:128 nt
buffer_load_dwordx4 v[80:83], v2, s[32:35], 0 offen offset:256 nt
L_kvrest:
s_waitcnt vmcnt(6)
s_lshr_b32 s62, s81, 9
s_mul_i32 s62, s62, 50331648
s_add_u32 s63, s81, s93
s_and_b32 s63, s63, 511
s_mul_i32 s63, s63, 3072
s_add_u32 s62, s62, s63
s_cmp_ge_u32 s81, 1024
s_cselect_b32 s62, 0xf0000000, s62
v_add_u32 v2, s62, v3
buffer_load_dwordx4 v[84:87], v2, s[28:31], 0 offen offset:0 nt
buffer_load_dwordx4 v[88:91], v2, s[28:31], 0 offen offset:128 nt
buffer_load_dwordx4 v[92:95], v2, s[28:31], 0 offen offset:256 nt
buffer_load_dwordx4 v[96:99], v2, s[32:35], 0 offen offset:0 nt
buffer_load_dwordx4 v[100:103], v2, s[32:35], 0 offen offset:128 nt
buffer_load_dwordx4 v[104:107], v2, s[32:35], 0 offen offset:256 nt
s_waitcnt vmcnt(6)
s_lshr_b32 s62, s82, 9
s_mul_i32 s62, s62, 50331648
s_add_u32 s63, s82, s93
s_and_b32 s63, s63, 511
s_mul_i32 s63, s63, 3072
s_add_u32 s62, s62, s63
s_cmp_ge_u32 s82, 1024
s_cselect_b32 s62, 0xf0000000, s62
v_add_u32 v2, s62, v3
buffer_load_dwordx4 v[108:111], v2, s[28:31], 0 offen offset:0 nt
buffer_load_dwordx4 v[112:115], v2, s[28:31], 0 offen offset:128 nt
buffer_load_dwordx4 v[116:119], v2, s[28:31], 0 offen offset:256 nt
buffer_load_dwordx4 v[120:123], v2, s[32:35], 0 offen offset:0 nt
buffer_load_dwordx4 v[124:127], v2, s[32:35], 0 offen offset:128 nt
buffer_load_dwordx4 v[128:131], v2, s[32:35], 0 offen offset:256 nt
s_waitcnt vmcnt(6)
s_lshr_b32 s62, s83, 9
s_mul_i32 s62, s62, 50331648
s_add_u32 s63, s83, s93
s_and_b32 s63, s63, 511
s_mul_i32 s63, s63, 3072
s_add_u32 s62, s62, s63
s_cmp_ge_u32 s83, 1024
s_cselect_b32 s62, 0xf0000000, s62
v_add_u32 v2, s62, v3
buffer_load_dwordx4 v[132:135], v2, s[28:31], 0 offen offset:0 nt
buffer_load_dwordx4 v[136:139], v2, s[28:31], 0 offen offset:128 nt
buffer_load_dwordx4 v[140:143], v2, s[28:31], 0 offen offset:256 nt
buffer_load_dwordx4 v[144:147], v2, s[32:35], 0 offen offset:0 nt
buffer_load_dwordx4 v[148:151], v2, s[32:35], 0 offen offset:128 nt
buffer_load_dwordx4 v[152:155], v2, s[32:35], 0 offen offset:256 nt
L_qwait:
v_and_b32 v6, 7, v1
v_lshlrev_b32 v6, 5, v6
v_lshrrev_b32 v7, 5, v1
v_lshl_add_u32 v6, v7, 4, v6
v_bfe_u32 v7, v1, 4, 1
v_lshl_add_u32 v6, v7, 3, v6
s_mul_i32 s62, s56, 768
v_add_u32 v236, s62, v6
v_and_b32 v5, 127, v0
v_lshrrev_b32 v4, 7, v0
v_mul_u32_u24 v6, 3072, v4
v_lshl_add_u32 v237, v5, 3, v6
v_lshlrev_b32 v238, 5, v4
v_lshlrev_b32 v6, 11, v4
v_lshl_add_u32 v239, v5, 4, v6
v_and_b32 v24, 7, v1
v_and_b32 v25, 1, v24
v_lshrrev_b32 v24, 1, v24
v_cmp_eq_u32 vcc, 1, v25
v_mov_b32 v26, 0x0c0c0100
v_mov_b32 v27, 0x01000c0c
v_mov_b32 v28, 0x0c0c0302
v_mov_b32 v29, 0x03020c0c
v_cndmask_b32 v26, v26, v27, vcc
v_cndmask_b32 v28, v28, v29, vcc
v_mov_b32 v27, 0x0c0c0c0c
v_cmp_eq_u32 vcc, 0, v24
s_nop 1
v_cndmask_b32 v240, v27, v26, vcc
v_cndmask_b32 v244, v27, v28, vcc
v_cmp_eq_u32 vcc, 1, v24
s_nop 1
v_cndmask_b32 v241, v27, v26, vcc
v_cndmask_b32 v245, v27, v28, vcc
v_cmp_eq_u32 vcc, 2, v24
s_nop 1
v_cndmask_b32 v242, v27, v26, vcc
v_cndmask_b32 v246, v27, v28, vcc
v_cmp_eq_u32 vcc, 3, v24
s_nop 1
v_cndmask_b32 v243, v27, v26, vcc
v_cndmask_b32 v247, v27, v28, vcc
v_lshrrev_b32 v6, 4, v1
v_mul_u32_u24 v6, 24, v6
v_bfe_u32 v7, v1, 3, 1
v_mul_u32_u24 v7, 384, v7
v_add_u32 v6, v6, v7
s_mul_i32 s62, s56, 96
v_add_u32 v248, s62, v6
v_lshrrev_b32 v6, 5, v1
v_lshlrev_b32 v6, 9, v6
v_and_b32 v7, 15, v1
v_lshl_add_u32 v6, v7, 5, v6
v_bfe_u32 v7, v1, 4, 1
v_lshl_add_u32 v6, v7, 4, v6
s_lshl_b32 s62, s56, 10
v_add_u32 v249, s62, v6
v_cmp_le_u32 vcc, 96, v0
s_nop 1
v_cndmask_b32 v7, 0, 1, vcc
v_mul_u32_u24 v5, 96, v7
v_sub_u32 v5, v0, v5
v_lshlrev_b32 v6, 11, v7
v_lshl_add_u32 v250, v5, 4, v6
v_mul_u32_u24 v6, 384, v7
v_lshl_add_u32 v251, v5, 2, v6
v_lshlrev_b32 v6, 4, v1
s_mul_i32 s62, s56, 12288
v_add_u32 v252, s62, v6
s_waitcnt lgkmcnt(0)
s_mul_i32 s60, s61, 0x9E3779B1
s_add_u32 s60, s60, 0x7F4A7C15
s_cmp_lg_u32 s56, 0
s_cbranch_scc1 L_qbar
s_setprio 2
s_lshl_b32 s62, s57, 13
s_add_u32 s62, s62, 16384
s_add_u32 s63, s62, 3072
v_lshlrev_b32 v6, 5, v1
v_and_b32 v7, 31, v1
v_lshlrev_b32 v7, 5, v7
v_add_u32 v7, 2048, v7
s_mov_b32 s3, 1048576
L_pq:
buffer_load_dwordx4 v[204:207], v6, s[40:43], s62 offen sc0 sc1
buffer_load_dwordx4 v[208:211], v6, s[40:43], s62 offen offset:16 sc0 sc1
buffer_load_dwordx4 v[212:215], v7, s[40:43], s62 offen sc0 sc1
buffer_load_dwordx4 v[216:219], v7, s[40:43], s62 offen offset:16 sc0 sc1
buffer_load_dwordx4 v[220:223], v6, s[40:43], s63 offen sc0 sc1
buffer_load_dwordx4 v[224:227], v6, s[40:43], s63 offen offset:16 sc0 sc1
buffer_load_dwordx4 v[228:231], v7, s[40:43], s63 offen sc0 sc1
buffer_load_dwordx4 v[232:235], v7, s[40:43], s63 offen offset:16 sc0 sc1
s_waitcnt vmcnt(0)
v_xor_b32 v52, s60, v205
v_bitop3_b32 v52, v52, v207, s60 bitop3:0xf6
v_bitop3_b32 v52, v52, v209, s60 bitop3:0xf6
v_bitop3_b32 v52, v52, v211, s60 bitop3:0xf6
v_bitop3_b32 v52, v52, v213, s60 bitop3:0xf6
v_bitop3_b32 v52, v52, v215, s60 bitop3:0xf6
v_bitop3_b32 v52, v52, v217, s60 bitop3:0xf6
v_bitop3_b32 v52, v52, v219, s60 bitop3:0xf6
v_bitop3_b32 v52, v52, v221, s60 bitop3:0xf6
v_bitop3_b32 v52, v52, v223, s60 bitop3:0xf6
v_bitop3_b32 v52, v52, v225, s60 bitop3:0xf6
v_bitop3_b32 v52, v52, v227, s60 bitop3:0xf6
v_bitop3_b32 v52, v52, v229, s60 bitop3:0xf6
v_bitop3_b32 v52, v52, v231, s60 bitop3:0xf6
v_bitop3_b32 v52, v52, v233, s60 bitop3:0xf6
v_bitop3_b32 v52, v52, v235, s60 bitop3:0xf6
v_cmp_ne_u32 vcc, 0, v52
s_mov_b64 exec, vcc
s_cbranch_execz L_pq_done
s_sub_u32 s3, s3, 1
s_cmp_lg_u32 s3, 0
s_cbranch_scc1 L_pq
L_pq_done:
s_mov_b64 exec, -1
v_lshlrev_b32 v6, 2, v1
v_and_b32 v7, 31, v1
v_lshlrev_b32 v7, 2, v7
v_add_f32 v204, v204, v208
v_add_f32 v206, v206, v210
v_add_f32 v212, v212, v216
v_add_f32 v214, v214, v218
v_cvt_pk_bf16_f32 v204, v204, v206
v_cvt_pk_bf16_f32 v212, v212, v214
ds_write_b32 v6, v204 offset:6656
ds_write_b32 v7, v212 offset:6912
v_add_f32 v220, v220, v224
v_add_f32 v222, v222, v226
v_add_f32 v228, v228, v232
v_add_f32 v230, v230, v234
v_cvt_pk_bf16_f32 v220, v220, v222
v_cvt_pk_bf16_f32 v228, v228, v230
ds_write_b32 v6, v220 offset:7040
ds_write_b32 v7, v228 offset:7296
s_waitcnt lgkmcnt(0)
s_setprio 0
s_mov_b32 s30, 51904512
s_mov_b32 s34, 51904512
L_qbar:
s_barrier
s_mov_b32 s86, 1
v_and_b32 v7, 7, v1
v_lshlrev_b32 v6, 4, v7
ds_read_b128 v[8:11], v6 offset:6656
ds_read_b128 v[12:15], v6 offset:6784
ds_read_b128 v[16:19], v6 offset:6912
s_lshr_b32 s62, s84, 9
s_mul_i32 s62, s62, 50331648
s_add_u32 s63, s84, s93
s_and_b32 s63, s63, 511
s_mul_i32 s63, s63, 3072
s_add_u32 s62, s62, s63
s_cmp_ge_u32 s84, 1024
s_cselect_b32 s62, 0xf0000000, s62
v_add_u32 v2, s62, v3
buffer_load_dwordx4 v[156:159], v2, s[28:31], 0 offen offset:0 nt
buffer_load_dwordx4 v[160:163], v2, s[28:31], 0 offen offset:128 nt
buffer_load_dwordx4 v[164:167], v2, s[28:31], 0 offen offset:256 nt
buffer_load_dwordx4 v[168:171], v2, s[32:35], 0 offen offset:0 nt
buffer_load_dwordx4 v[172:175], v2, s[32:35], 0 offen offset:128 nt
buffer_load_dwordx4 v[176:179], v2, s[32:35], 0 offen offset:256 nt
s_lshr_b32 s62, s85, 9
s_mul_i32 s62, s62, 50331648
s_add_u32 s63, s85, s93
s_and_b32 s63, s63, 511
s_mul_i32 s63, s63, 3072
s_add_u32 s62, s62, s63
s_cmp_ge_u32 s85, 1024
s_cselect_b32 s62, 0xf0000000, s62
v_add_u32 v2, s62, v3
buffer_load_dwordx4 v[180:183], v2, s[28:31], 0 offen offset:0 nt
buffer_load_dwordx4 v[184:187], v2, s[28:31], 0 offen offset:128 nt
buffer_load_dwordx4 v[188:191], v2, s[28:31], 0 offen offset:256 nt
buffer_load_dwordx4 v[192:195], v2, s[32:35], 0 offen offset:0 nt
buffer_load_dwordx4 v[196:199], v2, s[32:35], 0 offen offset:128 nt
buffer_load_dwordx4 v[200:203], v2, s[32:35], 0 offen offset:256 nt
s_mul_i32 s62, s57, 245760
s_max_u32 s63, s58, 3
s_sub_u32 s63, s63, 3
s_lshl_b32 s63, s63, 8
s_add_u32 s62, s62, s63
s_add_u32 s52, s12, s62
s_addc_u32 s53, s13, 0
s_cmp_lt_u32 s58, 3
s_cselect_b32 s54, 0, 244736
s_mov_b32 s55, 0x20000
v_lshrrev_b32 v6, 4, v1
v_mul_u32_u24 v6, 12, v6
s_mul_i32 s62, s56, 48
v_add_u32 v6, s62, v6
v_mul_u32_u24 v6, 1280, v6
v_and_b32 v7, 15, v1
v_lshl_add_u32 v254, v7, 4, v6
s_mul_i32 s24, s56, 12288
s_add_u32 s24, s24, 19968
s_mov_b32 m0, s24
s_mov_b32 s25, 0
s_lshl_b32 s62, s57, 15
s_add_u32 s4, s62, 327680
s_add_u32 s5, s4, 4096
s_add_u32 s6, s4, 8192
s_add_u32 s7, s4, 12288
s_add_u32 s8, s4, 16384
s_add_u32 s9, s4, 20480
s_add_u32 s10, s4, 24576
s_add_u32 s11, s4, 28672
s_lshl_b32 s63, s58, 12
s_add_u32 s13, s4, s63
s_mul_i32 s62, s57, 5
s_add_u32 s62, s62, s58
s_sub_u32 s62, s62, 3
s_lshl_b32 s62, s62, 11
s_add_u32 s12, s62, 1376256
v_mov_b32 v20, 0
v_mov_b32 v21, 0
v_mov_b32 v22, 0
v_mov_b32 v23, 0
v_mov_b32 v24, 0
v_mov_b32 v25, 0
v_mov_b32 v26, 0
v_mov_b32 v27, 0
v_mov_b32 v28, 0
v_mov_b32 v29, 0
v_mov_b32 v30, 0
v_mov_b32 v31, 0
v_mov_b32 v32, 0
v_mov_b32 v33, 0
v_mov_b32 v34, 0
v_mov_b32 v35, 0
v_mov_b32 v36, 0
v_mov_b32 v37, 0
v_mov_b32 v38, 0
v_mov_b32 v39, 0
v_mov_b32 v40, 0
v_mov_b32 v41, 0
v_mov_b32 v42, 0
v_mov_b32 v43, 0
v_mov_b32 v44, 0xff000000
v_mov_b32 v45, 0
v_lshlrev_b32 v6, 2, v1
s_mul_i32 s62, s56, 768
v_add_u32 v6, s62, v6
ds_write_b32 v6, v45 offset:7424
ds_write_b32 v6, v45 offset:7680
ds_write_b32 v6, v45 offset:7936
ds_write_b32 v6, v45 offset:10496
ds_write_b32 v6, v45 offset:10752
ds_write_b32 v6, v45 offset:11008
s_lshl_b32 s62, s56, 3
v_mov_b32 v7, s62
ds_write_b64 v7, v[44:45] offset:13568
ds_write_b64 v7, v[44:45] offset:13600
s_mov_b32 s59, 512
s_mov_b32 s21, 0
s_mov_b32 s14, 0x3d93cd3a
s_mov_b32 s15, 0x3fb8aa3b
s_waitcnt lgkmcnt(0)
s_atomic_add s86, s[88:89], 0 glc
s_waitcnt vmcnt(33)
v_mov_b32 v46, 0
v_mov_b32 v47, 0
v_dot2c_f32_bf16 v46, v60, v8
v_dot2c_f32_bf16 v47, v61, v9
v_dot2c_f32_bf16 v46, v62, v10
v_dot2c_f32_bf16 v47, v63, v11
v_dot2c_f32_bf16 v46, v64, v12
v_dot2c_f32_bf16 v47, v65, v13
v_dot2c_f32_bf16 v46, v66, v14
v_dot2c_f32_bf16 v47, v67, v15
v_dot2c_f32_bf16 v46, v68, v16
v_dot2c_f32_bf16 v47, v69, v17
v_dot2c_f32_bf16 v46, v70, v18
v_dot2c_f32_bf16 v47, v71, v19
s_nop 2
v_add_f32 v46, v46, v47
s_nop 1
v_add_f32_dpp v46, v46, v46 quad_perm:[1,0,3,2] row_mask:0xf bank_mask:0xf
s_nop 1
v_add_f32_dpp v46, v46, v46 quad_perm:[2,3,0,1] row_mask:0xf bank_mask:0xf
s_nop 1
v_add_f32_dpp v46, v46, v46 row_half_mirror row_mask:0xf bank_mask:0xf
v_cvt_pk_bf16_f32 v46, v46, v46
v_and_b32 v46, 0xffff0000, v46
v_mul_f32 v46, s14, v46
v_cvt_pk_bf16_f32 v46, v46, v46
v_and_b32 v46, 0xffff0000, v46
v_mul_f32 v46, s15, v46
v_max_f32 v47, v44, v46
v_sub_f32 v48, v44, v47
v_sub_f32 v49, v46, v47
v_exp_f32 v48, v48
v_exp_f32 v49, v49
v_mov_b32 v44, v47
v_fma_f32 v45, v45, v48, v49
v_cvt_pk_bf16_f32 v50, v49, 0
v_lshlrev_b32 v51, 16, v50
v_pk_mul_f32 v[20:21], v[20:21], v[48:49] op_sel_hi:[1,0]
v_pk_mul_f32 v[22:23], v[22:23], v[48:49] op_sel_hi:[1,0]
v_pk_mul_f32 v[24:25], v[24:25], v[48:49] op_sel_hi:[1,0]
v_pk_mul_f32 v[26:27], v[26:27], v[48:49] op_sel_hi:[1,0]
v_pk_mul_f32 v[28:29], v[28:29], v[48:49] op_sel_hi:[1,0]
v_pk_mul_f32 v[30:31], v[30:31], v[48:49] op_sel_hi:[1,0]
v_pk_mul_f32 v[32:33], v[32:33], v[48:49] op_sel_hi:[1,0]
v_pk_mul_f32 v[34:35], v[34:35], v[48:49] op_sel_hi:[1,0]
v_pk_mul_f32 v[36:37], v[36:37], v[48:49] op_sel_hi:[1,0]
v_pk_mul_f32 v[38:39], v[38:39], v[48:49] op_sel_hi:[1,0]
v_pk_mul_f32 v[40:41], v[40:41], v[48:49] op_sel_hi:[1,0]
v_pk_mul_f32 v[42:43], v[42:43], v[48:49] op_sel_hi:[1,0]
s_waitcnt vmcnt(30)
v_dot2c_f32_bf16 v20, v72, v50
v_dot2c_f32_bf16 v21, v72, v51
v_dot2c_f32_bf16 v22, v73, v50
v_dot2c_f32_bf16 v23, v73, v51
v_dot2c_f32_bf16 v24, v74, v50
v_dot2c_f32_bf16 v25, v74, v51
v_dot2c_f32_bf16 v26, v75, v50
v_dot2c_f32_bf16 v27, v75, v51
v_dot2c_f32_bf16 v28, v76, v50
v_dot2c_f32_bf16 v29, v76, v51
v_dot2c_f32_bf16 v30, v77, v50
v_dot2c_f32_bf16 v31, v77, v51
v_dot2c_f32_bf16 v32, v78, v50
v_dot2c_f32_bf16 v33, v78, v51
v_dot2c_f32_bf16 v34, v79, v50
v_dot2c_f32_bf16 v35, v79, v51
v_dot2c_f32_bf16 v36, v80, v50
v_dot2c_f32_bf16 v37, v80, v51
v_dot2c_f32_bf16 v38, v81, v50
v_dot2c_f32_bf16 v39, v81, v51
v_dot2c_f32_bf16 v40, v82, v50
v_dot2c_f32_bf16 v41, v82, v51
v_dot2c_f32_bf16 v42, v83, v50
v_dot2c_f32_bf16 v43, v83, v51
s_waitcnt lgkmcnt(0)
s_mov_b32 s80, s86
s_mov_b32 s86, 1
s_atomic_add s86, s[88:89], 0 glc
s_lshr_b32 s62, s80, 9
s_mul_i32 s62, s62, 50331648
s_add_u32 s63, s80, s93
s_and_b32 s63, s63, 511
s_mul_i32 s63, s63, 3072
s_add_u32 s62, s62, s63
s_cmp_ge_u32 s80, 1024
s_cselect_b32 s62, 0xf0000000, s62
v_add_u32 v2, s62, v3
buffer_load_dwordx4 v[60:63], v2, s[28:31], 0 offen offset:0 nt
buffer_load_dwordx4 v[64:67], v2, s[28:31], 0 offen offset:128 nt
buffer_load_dwordx4 v[68:71], v2, s[28:31], 0 offen offset:256 nt
buffer_load_dwordx4 v[72:75], v2, s[32:35], 0 offen offset:0 nt
buffer_load_dwordx4 v[76:79], v2, s[32:35], 0 offen offset:128 nt
buffer_load_dwordx4 v[80:83], v2, s[32:35], 0 offen offset:256 nt
s_waitcnt vmcnt(33)
v_mov_b32 v46, 0
v_mov_b32 v47, 0
v_dot2c_f32_bf16 v46, v84, v8
v_dot2c_f32_bf16 v47, v85, v9
v_dot2c_f32_bf16 v46, v86, v10
v_dot2c_f32_bf16 v47, v87, v11
v_dot2c_f32_bf16 v46, v88, v12
v_dot2c_f32_bf16 v47, v89, v13
v_dot2c_f32_bf16 v46, v90, v14
v_dot2c_f32_bf16 v47, v91, v15
v_dot2c_f32_bf16 v46, v92, v16
v_dot2c_f32_bf16 v47, v93, v17
v_dot2c_f32_bf16 v46, v94, v18
v_dot2c_f32_bf16 v47, v95, v19
s_nop 2
v_add_f32 v46, v46, v47
s_nop 1
v_add_f32_dpp v46, v46, v46 quad_perm:[1,0,3,2] row_mask:0xf bank_mask:0xf
s_nop 1
v_add_f32_dpp v46, v46, v46 quad_perm:[2,3,0,1] row_mask:0xf bank_mask:0xf
s_nop 1
v_add_f32_dpp v46, v46, v46 row_half_mirror row_mask:0xf bank_mask:0xf
v_cvt_pk_bf16_f32 v46, v46, v46
v_and_b32 v46, 0xffff0000, v46
v_mul_f32 v46, s14, v46
v_cvt_pk_bf16_f32 v46, v46, v46
v_and_b32 v46, 0xffff0000, v46
v_mul_f32 v46, s15, v46
v_max_f32 v47, v44, v46
v_sub_f32 v48, v44, v47
v_sub_f32 v49, v46, v47
v_exp_f32 v48, v48
v_exp_f32 v49, v49
v_mov_b32 v44, v47
v_fma_f32 v45, v45, v48, v49
v_cvt_pk_bf16_f32 v50, v49, 0
v_lshlrev_b32 v51, 16, v50
v_pk_mul_f32 v[20:21], v[20:21], v[48:49] op_sel_hi:[1,0]
v_pk_mul_f32 v[22:23], v[22:23], v[48:49] op_sel_hi:[1,0]
v_pk_mul_f32 v[24:25], v[24:25], v[48:49] op_sel_hi:[1,0]
v_pk_mul_f32 v[26:27], v[26:27], v[48:49] op_sel_hi:[1,0]
v_pk_mul_f32 v[28:29], v[28:29], v[48:49] op_sel_hi:[1,0]
v_pk_mul_f32 v[30:31], v[30:31], v[48:49] op_sel_hi:[1,0]
v_pk_mul_f32 v[32:33], v[32:33], v[48:49] op_sel_hi:[1,0]
v_pk_mul_f32 v[34:35], v[34:35], v[48:49] op_sel_hi:[1,0]
v_pk_mul_f32 v[36:37], v[36:37], v[48:49] op_sel_hi:[1,0]
v_pk_mul_f32 v[38:39], v[38:39], v[48:49] op_sel_hi:[1,0]
v_pk_mul_f32 v[40:41], v[40:41], v[48:49] op_sel_hi:[1,0]
v_pk_mul_f32 v[42:43], v[42:43], v[48:49] op_sel_hi:[1,0]
s_waitcnt vmcnt(30)
v_dot2c_f32_bf16 v20, v96, v50
v_dot2c_f32_bf16 v21, v96, v51
v_dot2c_f32_bf16 v22, v97, v50
v_dot2c_f32_bf16 v23, v97, v51
v_dot2c_f32_bf16 v24, v98, v50
v_dot2c_f32_bf16 v25, v98, v51
v_dot2c_f32_bf16 v26, v99, v50
v_dot2c_f32_bf16 v27, v99, v51
v_dot2c_f32_bf16 v28, v100, v50
v_dot2c_f32_bf16 v29, v100, v51
v_dot2c_f32_bf16 v30, v101, v50
v_dot2c_f32_bf16 v31, v101, v51
v_dot2c_f32_bf16 v32, v102, v50
v_dot2c_f32_bf16 v33, v102, v51
v_dot2c_f32_bf16 v34, v103, v50
v_dot2c_f32_bf16 v35, v103, v51
v_dot2c_f32_bf16 v36, v104, v50
v_dot2c_f32_bf16 v37, v104, v51
v_dot2c_f32_bf16 v38, v105, v50
v_dot2c_f32_bf16 v39, v105, v51
v_dot2c_f32_bf16 v40, v106, v50
v_dot2c_f32_bf16 v41, v106, v51
v_dot2c_f32_bf16 v42, v107, v50
v_dot2c_f32_bf16 v43, v107, v51
s_waitcnt lgkmcnt(0)
s_mov_b32 s81, s86
s_mov_b32 s86, 1
s_atomic_add s86, s[88:89], 0 glc
s_lshr_b32 s62, s81, 9
s_mul_i32 s62, s62, 50331648
s_add_u32 s63, s81, s93
s_and_b32 s63, s63, 511
s_mul_i32 s63, s63, 3072
s_add_u32 s62, s62, s63
s_cmp_ge_u32 s81, 1024
s_cselect_b32 s62, 0xf0000000, s62
v_add_u32 v2, s62, v3
buffer_load_dwordx4 v[84:87], v2, s[28:31], 0 offen offset:0 nt
buffer_load_dwordx4 v[88:91], v2, s[28:31], 0 offen offset:128 nt
buffer_load_dwordx4 v[92:95], v2, s[28:31], 0 offen offset:256 nt
buffer_load_dwordx4 v[96:99], v2, s[32:35], 0 offen offset:0 nt
buffer_load_dwordx4 v[100:103], v2, s[32:35], 0 offen offset:128 nt
buffer_load_dwordx4 v[104:107], v2, s[32:35], 0 offen offset:256 nt
s_waitcnt vmcnt(33)
v_mov_b32 v46, 0
v_mov_b32 v47, 0
v_dot2c_f32_bf16 v46, v108, v8
v_dot2c_f32_bf16 v47, v109, v9
v_dot2c_f32_bf16 v46, v110, v10
v_dot2c_f32_bf16 v47, v111, v11
v_dot2c_f32_bf16 v46, v112, v12
v_dot2c_f32_bf16 v47, v113, v13
v_dot2c_f32_bf16 v46, v114, v14
v_dot2c_f32_bf16 v47, v115, v15
v_dot2c_f32_bf16 v46, v116, v16
v_dot2c_f32_bf16 v47, v117, v17
v_dot2c_f32_bf16 v46, v118, v18
v_dot2c_f32_bf16 v47, v119, v19
s_nop 2
v_add_f32 v46, v46, v47
s_nop 1
v_add_f32_dpp v46, v46, v46 quad_perm:[1,0,3,2] row_mask:0xf bank_mask:0xf
s_nop 1
v_add_f32_dpp v46, v46, v46 quad_perm:[2,3,0,1] row_mask:0xf bank_mask:0xf
s_nop 1
v_add_f32_dpp v46, v46, v46 row_half_mirror row_mask:0xf bank_mask:0xf
v_cvt_pk_bf16_f32 v46, v46, v46
v_and_b32 v46, 0xffff0000, v46
v_mul_f32 v46, s14, v46
v_cvt_pk_bf16_f32 v46, v46, v46
v_and_b32 v46, 0xffff0000, v46
v_mul_f32 v46, s15, v46
v_max_f32 v47, v44, v46
v_sub_f32 v48, v44, v47
v_sub_f32 v49, v46, v47
v_exp_f32 v48, v48
v_exp_f32 v49, v49
v_mov_b32 v44, v47
v_fma_f32 v45, v45, v48, v49
v_cvt_pk_bf16_f32 v50, v49, 0
v_lshlrev_b32 v51, 16, v50
v_pk_mul_f32 v[20:21], v[20:21], v[48:49] op_sel_hi:[1,0]
v_pk_mul_f32 v[22:23], v[22:23], v[48:49] op_sel_hi:[1,0]
v_pk_mul_f32 v[24:25], v[24:25], v[48:49] op_sel_hi:[1,0]
v_pk_mul_f32 v[26:27], v[26:27], v[48:49] op_sel_hi:[1,0]
v_pk_mul_f32 v[28:29], v[28:29], v[48:49] op_sel_hi:[1,0]
v_pk_mul_f32 v[30:31], v[30:31], v[48:49] op_sel_hi:[1,0]
v_pk_mul_f32 v[32:33], v[32:33], v[48:49] op_sel_hi:[1,0]
v_pk_mul_f32 v[34:35], v[34:35], v[48:49] op_sel_hi:[1,0]
v_pk_mul_f32 v[36:37], v[36:37], v[48:49] op_sel_hi:[1,0]
v_pk_mul_f32 v[38:39], v[38:39], v[48:49] op_sel_hi:[1,0]
v_pk_mul_f32 v[40:41], v[40:41], v[48:49] op_sel_hi:[1,0]
v_pk_mul_f32 v[42:43], v[42:43], v[48:49] op_sel_hi:[1,0]
s_waitcnt vmcnt(30)
v_dot2c_f32_bf16 v20, v120, v50
v_dot2c_f32_bf16 v21, v120, v51
v_dot2c_f32_bf16 v22, v121, v50
v_dot2c_f32_bf16 v23, v121, v51
v_dot2c_f32_bf16 v24, v122, v50
v_dot2c_f32_bf16 v25, v122, v51
v_dot2c_f32_bf16 v26, v123, v50
v_dot2c_f32_bf16 v27, v123, v51
v_dot2c_f32_bf16 v28, v124, v50
v_dot2c_f32_bf16 v29, v124, v51
v_dot2c_f32_bf16 v30, v125, v50
v_dot2c_f32_bf16 v31, v125, v51
v_dot2c_f32_bf16 v32, v126, v50
v_dot2c_f32_bf16 v33, v126, v51
v_dot2c_f32_bf16 v34, v127, v50
v_dot2c_f32_bf16 v35, v127, v51
v_dot2c_f32_bf16 v36, v128, v50
v_dot2c_f32_bf16 v37, v128, v51
v_dot2c_f32_bf16 v38, v129, v50
v_dot2c_f32_bf16 v39, v129, v51
v_dot2c_f32_bf16 v40, v130, v50
v_dot2c_f32_bf16 v41, v130, v51
v_dot2c_f32_bf16 v42, v131, v50
v_dot2c_f32_bf16 v43, v131, v51
s_waitcnt vmcnt(27)
v_mov_b32 v46, 0
v_mov_b32 v47, 0
v_dot2c_f32_bf16 v46, v132, v8
v_dot2c_f32_bf16 v47, v133, v9
v_dot2c_f32_bf16 v46, v134, v10
v_dot2c_f32_bf16 v47, v135, v11
v_dot2c_f32_bf16 v46, v136, v12
v_dot2c_f32_bf16 v47, v137, v13
v_dot2c_f32_bf16 v46, v138, v14
v_dot2c_f32_bf16 v47, v139, v15
v_dot2c_f32_bf16 v46, v140, v16
v_dot2c_f32_bf16 v47, v141, v17
v_dot2c_f32_bf16 v46, v142, v18
v_dot2c_f32_bf16 v47, v143, v19
s_nop 2
v_add_f32 v46, v46, v47
s_nop 1
v_add_f32_dpp v46, v46, v46 quad_perm:[1,0,3,2] row_mask:0xf bank_mask:0xf
s_nop 1
v_add_f32_dpp v46, v46, v46 quad_perm:[2,3,0,1] row_mask:0xf bank_mask:0xf
s_nop 1
v_add_f32_dpp v46, v46, v46 row_half_mirror row_mask:0xf bank_mask:0xf
v_cvt_pk_bf16_f32 v46, v46, v46
v_and_b32 v46, 0xffff0000, v46
v_mul_f32 v46, s14, v46
v_cvt_pk_bf16_f32 v46, v46, v46
v_and_b32 v46, 0xffff0000, v46
v_mul_f32 v46, s15, v46
v_max_f32 v47, v44, v46
v_sub_f32 v48, v44, v47
v_sub_f32 v49, v46, v47
v_exp_f32 v48, v48
v_exp_f32 v49, v49
v_mov_b32 v44, v47
v_fma_f32 v45, v45, v48, v49
v_cvt_pk_bf16_f32 v50, v49, 0
v_lshlrev_b32 v51, 16, v50
v_pk_mul_f32 v[20:21], v[20:21], v[48:49] op_sel_hi:[1,0]
v_pk_mul_f32 v[22:23], v[22:23], v[48:49] op_sel_hi:[1,0]
v_pk_mul_f32 v[24:25], v[24:25], v[48:49] op_sel_hi:[1,0]
v_pk_mul_f32 v[26:27], v[26:27], v[48:49] op_sel_hi:[1,0]
v_pk_mul_f32 v[28:29], v[28:29], v[48:49] op_sel_hi:[1,0]
v_pk_mul_f32 v[30:31], v[30:31], v[48:49] op_sel_hi:[1,0]
v_pk_mul_f32 v[32:33], v[32:33], v[48:49] op_sel_hi:[1,0]
v_pk_mul_f32 v[34:35], v[34:35], v[48:49] op_sel_hi:[1,0]
v_pk_mul_f32 v[36:37], v[36:37], v[48:49] op_sel_hi:[1,0]
v_pk_mul_f32 v[38:39], v[38:39], v[48:49] op_sel_hi:[1,0]
v_pk_mul_f32 v[40:41], v[40:41], v[48:49] op_sel_hi:[1,0]
v_pk_mul_f32 v[42:43], v[42:43], v[48:49] op_sel_hi:[1,0]
s_waitcnt vmcnt(24)
v_dot2c_f32_bf16 v20, v144, v50
v_dot2c_f32_bf16 v21, v144, v51
v_dot2c_f32_bf16 v22, v145, v50
v_dot2c_f32_bf16 v23, v145, v51
v_dot2c_f32_bf16 v24, v146, v50
v_dot2c_f32_bf16 v25, v146, v51
v_dot2c_f32_bf16 v26, v147, v50
v_dot2c_f32_bf16 v27, v147, v51
v_dot2c_f32_bf16 v28, v148, v50
v_dot2c_f32_bf16 v29, v148, v51
v_dot2c_f32_bf16 v30, v149, v50
v_dot2c_f32_bf16 v31, v149, v51
v_dot2c_f32_bf16 v32, v150, v50
v_dot2c_f32_bf16 v33, v150, v51
v_dot2c_f32_bf16 v34, v151, v50
v_dot2c_f32_bf16 v35, v151, v51
v_dot2c_f32_bf16 v36, v152, v50
v_dot2c_f32_bf16 v37, v152, v51
v_dot2c_f32_bf16 v38, v153, v50
v_dot2c_f32_bf16 v39, v153, v51
v_dot2c_f32_bf16 v40, v154, v50
v_dot2c_f32_bf16 v41, v154, v51
v_dot2c_f32_bf16 v42, v155, v50
v_dot2c_f32_bf16 v43, v155, v51
s_waitcnt vmcnt(21)
v_mov_b32 v46, 0
v_mov_b32 v47, 0
v_dot2c_f32_bf16 v46, v156, v8
v_dot2c_f32_bf16 v47, v157, v9
v_dot2c_f32_bf16 v46, v158, v10
v_dot2c_f32_bf16 v47, v159, v11
v_dot2c_f32_bf16 v46, v160, v12
v_dot2c_f32_bf16 v47, v161, v13
v_dot2c_f32_bf16 v46, v162, v14
v_dot2c_f32_bf16 v47, v163, v15
v_dot2c_f32_bf16 v46, v164, v16
v_dot2c_f32_bf16 v47, v165, v17
v_dot2c_f32_bf16 v46, v166, v18
v_dot2c_f32_bf16 v47, v167, v19
s_nop 2
v_add_f32 v46, v46, v47
s_nop 1
v_add_f32_dpp v46, v46, v46 quad_perm:[1,0,3,2] row_mask:0xf bank_mask:0xf
s_nop 1
v_add_f32_dpp v46, v46, v46 quad_perm:[2,3,0,1] row_mask:0xf bank_mask:0xf
s_nop 1
v_add_f32_dpp v46, v46, v46 row_half_mirror row_mask:0xf bank_mask:0xf
v_cvt_pk_bf16_f32 v46, v46, v46
v_and_b32 v46, 0xffff0000, v46
v_mul_f32 v46, s14, v46
v_cvt_pk_bf16_f32 v46, v46, v46
v_and_b32 v46, 0xffff0000, v46
v_mul_f32 v46, s15, v46
v_max_f32 v47, v44, v46
v_sub_f32 v48, v44, v47
v_sub_f32 v49, v46, v47
v_exp_f32 v48, v48
v_exp_f32 v49, v49
v_mov_b32 v44, v47
v_fma_f32 v45, v45, v48, v49
v_cvt_pk_bf16_f32 v50, v49, 0
v_lshlrev_b32 v51, 16, v50
v_pk_mul_f32 v[20:21], v[20:21], v[48:49] op_sel_hi:[1,0]
v_pk_mul_f32 v[22:23], v[22:23], v[48:49] op_sel_hi:[1,0]
v_pk_mul_f32 v[24:25], v[24:25], v[48:49] op_sel_hi:[1,0]
v_pk_mul_f32 v[26:27], v[26:27], v[48:49] op_sel_hi:[1,0]
v_pk_mul_f32 v[28:29], v[28:29], v[48:49] op_sel_hi:[1,0]
v_pk_mul_f32 v[30:31], v[30:31], v[48:49] op_sel_hi:[1,0]
v_pk_mul_f32 v[32:33], v[32:33], v[48:49] op_sel_hi:[1,0]
v_pk_mul_f32 v[34:35], v[34:35], v[48:49] op_sel_hi:[1,0]
v_pk_mul_f32 v[36:37], v[36:37], v[48:49] op_sel_hi:[1,0]
v_pk_mul_f32 v[38:39], v[38:39], v[48:49] op_sel_hi:[1,0]
v_pk_mul_f32 v[40:41], v[40:41], v[48:49] op_sel_hi:[1,0]
v_pk_mul_f32 v[42:43], v[42:43], v[48:49] op_sel_hi:[1,0]
s_waitcnt vmcnt(18)
v_dot2c_f32_bf16 v20, v168, v50
v_dot2c_f32_bf16 v21, v168, v51
v_dot2c_f32_bf16 v22, v169, v50
v_dot2c_f32_bf16 v23, v169, v51
v_dot2c_f32_bf16 v24, v170, v50
v_dot2c_f32_bf16 v25, v170, v51
v_dot2c_f32_bf16 v26, v171, v50
v_dot2c_f32_bf16 v27, v171, v51
v_dot2c_f32_bf16 v28, v172, v50
v_dot2c_f32_bf16 v29, v172, v51
v_dot2c_f32_bf16 v30, v173, v50
v_dot2c_f32_bf16 v31, v173, v51
v_dot2c_f32_bf16 v32, v174, v50
v_dot2c_f32_bf16 v33, v174, v51
v_dot2c_f32_bf16 v34, v175, v50
v_dot2c_f32_bf16 v35, v175, v51
v_dot2c_f32_bf16 v36, v176, v50
v_dot2c_f32_bf16 v37, v176, v51
v_dot2c_f32_bf16 v38, v177, v50
v_dot2c_f32_bf16 v39, v177, v51
v_dot2c_f32_bf16 v40, v178, v50
v_dot2c_f32_bf16 v41, v178, v51
v_dot2c_f32_bf16 v42, v179, v50
v_dot2c_f32_bf16 v43, v179, v51
s_waitcnt vmcnt(15)
v_mov_b32 v46, 0
v_mov_b32 v47, 0
v_dot2c_f32_bf16 v46, v180, v8
v_dot2c_f32_bf16 v47, v181, v9
v_dot2c_f32_bf16 v46, v182, v10
v_dot2c_f32_bf16 v47, v183, v11
v_dot2c_f32_bf16 v46, v184, v12
v_dot2c_f32_bf16 v47, v185, v13
v_dot2c_f32_bf16 v46, v186, v14
v_dot2c_f32_bf16 v47, v187, v15
v_dot2c_f32_bf16 v46, v188, v16
v_dot2c_f32_bf16 v47, v189, v17
v_dot2c_f32_bf16 v46, v190, v18
v_dot2c_f32_bf16 v47, v191, v19
s_nop 2
v_add_f32 v46, v46, v47
s_nop 1
v_add_f32_dpp v46, v46, v46 quad_perm:[1,0,3,2] row_mask:0xf bank_mask:0xf
s_nop 1
v_add_f32_dpp v46, v46, v46 quad_perm:[2,3,0,1] row_mask:0xf bank_mask:0xf
s_nop 1
v_add_f32_dpp v46, v46, v46 row_half_mirror row_mask:0xf bank_mask:0xf
v_cvt_pk_bf16_f32 v46, v46, v46
v_and_b32 v46, 0xffff0000, v46
v_mul_f32 v46, s14, v46
v_cvt_pk_bf16_f32 v46, v46, v46
v_and_b32 v46, 0xffff0000, v46
v_mul_f32 v46, s15, v46
v_max_f32 v47, v44, v46
v_sub_f32 v48, v44, v47
v_sub_f32 v49, v46, v47
v_exp_f32 v48, v48
v_exp_f32 v49, v49
v_mov_b32 v44, v47
v_fma_f32 v45, v45, v48, v49
v_cvt_pk_bf16_f32 v50, v49, 0
v_lshlrev_b32 v51, 16, v50
v_pk_mul_f32 v[20:21], v[20:21], v[48:49] op_sel_hi:[1,0]
v_pk_mul_f32 v[22:23], v[22:23], v[48:49] op_sel_hi:[1,0]
v_pk_mul_f32 v[24:25], v[24:25], v[48:49] op_sel_hi:[1,0]
v_pk_mul_f32 v[26:27], v[26:27], v[48:49] op_sel_hi:[1,0]
v_pk_mul_f32 v[28:29], v[28:29], v[48:49] op_sel_hi:[1,0]
v_pk_mul_f32 v[30:31], v[30:31], v[48:49] op_sel_hi:[1,0]
v_pk_mul_f32 v[32:33], v[32:33], v[48:49] op_sel_hi:[1,0]
v_pk_mul_f32 v[34:35], v[34:35], v[48:49] op_sel_hi:[1,0]
v_pk_mul_f32 v[36:37], v[36:37], v[48:49] op_sel_hi:[1,0]
v_pk_mul_f32 v[38:39], v[38:39], v[48:49] op_sel_hi:[1,0]
v_pk_mul_f32 v[40:41], v[40:41], v[48:49] op_sel_hi:[1,0]
v_pk_mul_f32 v[42:43], v[42:43], v[48:49] op_sel_hi:[1,0]
s_waitcnt vmcnt(12)
v_dot2c_f32_bf16 v20, v192, v50
v_dot2c_f32_bf16 v21, v192, v51
v_dot2c_f32_bf16 v22, v193, v50
v_dot2c_f32_bf16 v23, v193, v51
v_dot2c_f32_bf16 v24, v194, v50
v_dot2c_f32_bf16 v25, v194, v51
v_dot2c_f32_bf16 v26, v195, v50
v_dot2c_f32_bf16 v27, v195, v51
v_dot2c_f32_bf16 v28, v196, v50
v_dot2c_f32_bf16 v29, v196, v51
v_dot2c_f32_bf16 v30, v197, v50
v_dot2c_f32_bf16 v31, v197, v51
v_dot2c_f32_bf16 v32, v198, v50
v_dot2c_f32_bf16 v33, v198, v51
v_dot2c_f32_bf16 v34, v199, v50
v_dot2c_f32_bf16 v35, v199, v51
v_dot2c_f32_bf16 v36, v200, v50
v_dot2c_f32_bf16 v37, v200, v51
v_dot2c_f32_bf16 v38, v201, v50
v_dot2c_f32_bf16 v39, v201, v51
v_dot2c_f32_bf16 v40, v202, v50
v_dot2c_f32_bf16 v41, v202, v51
v_dot2c_f32_bf16 v42, v203, v50
v_dot2c_f32_bf16 v43, v203, v51
L_loop:
s_cmp_ge_u32 s80, s59
s_cbranch_scc1 L_sw_0
L_cont_0:
s_waitcnt vmcnt(9)
v_mov_b32 v46, 0
v_mov_b32 v47, 0
v_dot2c_f32_bf16 v46, v60, v8
v_dot2c_f32_bf16 v47, v61, v9
v_dot2c_f32_bf16 v46, v62, v10
v_dot2c_f32_bf16 v47, v63, v11
v_dot2c_f32_bf16 v46, v64, v12
v_dot2c_f32_bf16 v47, v65, v13
v_dot2c_f32_bf16 v46, v66, v14
v_dot2c_f32_bf16 v47, v67, v15
v_dot2c_f32_bf16 v46, v68, v16
v_dot2c_f32_bf16 v47, v69, v17
v_dot2c_f32_bf16 v46, v70, v18
v_dot2c_f32_bf16 v47, v71, v19
s_nop 2
v_add_f32 v46, v46, v47
s_nop 1
v_add_f32_dpp v46, v46, v46 quad_perm:[1,0,3,2] row_mask:0xf bank_mask:0xf
s_nop 1
v_add_f32_dpp v46, v46, v46 quad_perm:[2,3,0,1] row_mask:0xf bank_mask:0xf
s_nop 1
v_add_f32_dpp v46, v46, v46 row_half_mirror row_mask:0xf bank_mask:0xf
v_cvt_pk_bf16_f32 v46, v46, v46
v_and_b32 v46, 0xffff0000, v46
v_mul_f32 v46, s14, v46
v_cvt_pk_bf16_f32 v46, v46, v46
v_and_b32 v46, 0xffff0000, v46
v_mul_f32 v46, s15, v46
v_max_f32 v47, v44, v46
v_sub_f32 v48, v44, v47
v_sub_f32 v49, v46, v47
v_exp_f32 v48, v48
v_exp_f32 v49, v49
v_mov_b32 v44, v47
v_fma_f32 v45, v45, v48, v49
v_cvt_pk_bf16_f32 v50, v49, 0
v_lshlrev_b32 v51, 16, v50
v_pk_mul_f32 v[20:21], v[20:21], v[48:49] op_sel_hi:[1,0]
v_pk_mul_f32 v[22:23], v[22:23], v[48:49] op_sel_hi:[1,0]
v_pk_mul_f32 v[24:25], v[24:25], v[48:49] op_sel_hi:[1,0]
v_pk_mul_f32 v[26:27], v[26:27], v[48:49] op_sel_hi:[1,0]
v_pk_mul_f32 v[28:29], v[28:29], v[48:49] op_sel_hi:[1,0]
v_pk_mul_f32 v[30:31], v[30:31], v[48:49] op_sel_hi:[1,0]
v_pk_mul_f32 v[32:33], v[32:33], v[48:49] op_sel_hi:[1,0]
v_pk_mul_f32 v[34:35], v[34:35], v[48:49] op_sel_hi:[1,0]
v_pk_mul_f32 v[36:37], v[36:37], v[48:49] op_sel_hi:[1,0]
v_pk_mul_f32 v[38:39], v[38:39], v[48:49] op_sel_hi:[1,0]
v_pk_mul_f32 v[40:41], v[40:41], v[48:49] op_sel_hi:[1,0]
v_pk_mul_f32 v[42:43], v[42:43], v[48:49] op_sel_hi:[1,0]
s_waitcnt vmcnt(6)
v_dot2c_f32_bf16 v20, v72, v50
v_dot2c_f32_bf16 v21, v72, v51
v_dot2c_f32_bf16 v22, v73, v50
v_dot2c_f32_bf16 v23, v73, v51
v_dot2c_f32_bf16 v24, v74, v50
v_dot2c_f32_bf16 v25, v74, v51
v_dot2c_f32_bf16 v26, v75, v50
v_dot2c_f32_bf16 v27, v75, v51
v_dot2c_f32_bf16 v28, v76, v50
v_dot2c_f32_bf16 v29, v76, v51
v_dot2c_f32_bf16 v30, v77, v50
v_dot2c_f32_bf16 v31, v77, v51
v_dot2c_f32_bf16 v32, v78, v50
v_dot2c_f32_bf16 v33, v78, v51
v_dot2c_f32_bf16 v34, v79, v50
v_dot2c_f32_bf16 v35, v79, v51
v_dot2c_f32_bf16 v36, v80, v50
v_dot2c_f32_bf16 v37, v80, v51
v_dot2c_f32_bf16 v38, v81, v50
v_dot2c_f32_bf16 v39, v81, v51
v_dot2c_f32_bf16 v40, v82, v50
v_dot2c_f32_bf16 v41, v82, v51
v_dot2c_f32_bf16 v42, v83, v50
v_dot2c_f32_bf16 v43, v83, v51
s_waitcnt lgkmcnt(0)
s_mov_b32 s80, s86
s_mov_b32 s86, 1
s_atomic_add s86, s[88:89], 0 glc
s_cmp_ge_u32 s80, 1024
s_cbranch_scc1 L_dma_0
s_lshr_b32 s62, s80, 9
s_mul_i32 s62, s62, 50331648
s_add_u32 s63, s80, s93
s_and_b32 s63, s63, 511
s_mul_i32 s63, s63, 3072
s_add_u32 s62, s62, s63
s_cmp_ge_u32 s80, 1024
s_cselect_b32 s62, 0xf0000000, s62
v_add_u32 v2, s62, v3
buffer_load_dwordx4 v[60:63], v2, s[28:31], 0 offen offset:0 nt
buffer_load_dwordx4 v[64:67], v2, s[28:31], 0 offen offset:128 nt
buffer_load_dwordx4 v[68:71], v2, s[28:31], 0 offen offset:256 nt
buffer_load_dwordx4 v[72:75], v2, s[32:35], 0 offen offset:0 nt
buffer_load_dwordx4 v[76:79], v2, s[32:35], 0 offen offset:128 nt
buffer_load_dwordx4 v[80:83], v2, s[32:35], 0 offen offset:256 nt
L_rj_0:
s_cmp_ge_u32 s81, s59
s_cbranch_scc1 L_sw_1
L_cont_1:
s_waitcnt vmcnt(9)
v_mov_b32 v46, 0
v_mov_b32 v47, 0
v_dot2c_f32_bf16 v46, v84, v8
v_dot2c_f32_bf16 v47, v85, v9
v_dot2c_f32_bf16 v46, v86, v10
v_dot2c_f32_bf16 v47, v87, v11
v_dot2c_f32_bf16 v46, v88, v12
v_dot2c_f32_bf16 v47, v89, v13
v_dot2c_f32_bf16 v46, v90, v14
v_dot2c_f32_bf16 v47, v91, v15
v_dot2c_f32_bf16 v46, v92, v16
v_dot2c_f32_bf16 v47, v93, v17
v_dot2c_f32_bf16 v46, v94, v18
v_dot2c_f32_bf16 v47, v95, v19
s_nop 2
v_add_f32 v46, v46, v47
s_nop 1
v_add_f32_dpp v46, v46, v46 quad_perm:[1,0,3,2] row_mask:0xf bank_mask:0xf
s_nop 1
v_add_f32_dpp v46, v46, v46 quad_perm:[2,3,0,1] row_mask:0xf bank_mask:0xf
s_nop 1
v_add_f32_dpp v46, v46, v46 row_half_mirror row_mask:0xf bank_mask:0xf
v_cvt_pk_bf16_f32 v46, v46, v46
v_and_b32 v46, 0xffff0000, v46
v_mul_f32 v46, s14, v46
v_cvt_pk_bf16_f32 v46, v46, v46
v_and_b32 v46, 0xffff0000, v46
v_mul_f32 v46, s15, v46
v_max_f32 v47, v44, v46
v_sub_f32 v48, v44, v47
v_sub_f32 v49, v46, v47
v_exp_f32 v48, v48
v_exp_f32 v49, v49
v_mov_b32 v44, v47
v_fma_f32 v45, v45, v48, v49
v_cvt_pk_bf16_f32 v50, v49, 0
v_lshlrev_b32 v51, 16, v50
v_pk_mul_f32 v[20:21], v[20:21], v[48:49] op_sel_hi:[1,0]
v_pk_mul_f32 v[22:23], v[22:23], v[48:49] op_sel_hi:[1,0]
v_pk_mul_f32 v[24:25], v[24:25], v[48:49] op_sel_hi:[1,0]
v_pk_mul_f32 v[26:27], v[26:27], v[48:49] op_sel_hi:[1,0]
v_pk_mul_f32 v[28:29], v[28:29], v[48:49] op_sel_hi:[1,0]
v_pk_mul_f32 v[30:31], v[30:31], v[48:49] op_sel_hi:[1,0]
v_pk_mul_f32 v[32:33], v[32:33], v[48:49] op_sel_hi:[1,0]
v_pk_mul_f32 v[34:35], v[34:35], v[48:49] op_sel_hi:[1,0]
v_pk_mul_f32 v[36:37], v[36:37], v[48:49] op_sel_hi:[1,0]
v_pk_mul_f32 v[38:39], v[38:39], v[48:49] op_sel_hi:[1,0]
v_pk_mul_f32 v[40:41], v[40:41], v[48:49] op_sel_hi:[1,0]
v_pk_mul_f32 v[42:43], v[42:43], v[48:49] op_sel_hi:[1,0]
s_waitcnt vmcnt(6)
v_dot2c_f32_bf16 v20, v96, v50
v_dot2c_f32_bf16 v21, v96, v51
v_dot2c_f32_bf16 v22, v97, v50
v_dot2c_f32_bf16 v23, v97, v51
v_dot2c_f32_bf16 v24, v98, v50
v_dot2c_f32_bf16 v25, v98, v51
v_dot2c_f32_bf16 v26, v99, v50
v_dot2c_f32_bf16 v27, v99, v51
v_dot2c_f32_bf16 v28, v100, v50
v_dot2c_f32_bf16 v29, v100, v51
v_dot2c_f32_bf16 v30, v101, v50
v_dot2c_f32_bf16 v31, v101, v51
v_dot2c_f32_bf16 v32, v102, v50
v_dot2c_f32_bf16 v33, v102, v51
v_dot2c_f32_bf16 v34, v103, v50
v_dot2c_f32_bf16 v35, v103, v51
v_dot2c_f32_bf16 v36, v104, v50
v_dot2c_f32_bf16 v37, v104, v51
v_dot2c_f32_bf16 v38, v105, v50
v_dot2c_f32_bf16 v39, v105, v51
v_dot2c_f32_bf16 v40, v106, v50
v_dot2c_f32_bf16 v41, v106, v51
v_dot2c_f32_bf16 v42, v107, v50
v_dot2c_f32_bf16 v43, v107, v51
s_waitcnt lgkmcnt(0)
s_mov_b32 s81, s86
s_mov_b32 s86, 1
s_atomic_add s86, s[88:89], 0 glc
s_cmp_ge_u32 s81, 1024
s_cbranch_scc1 L_dma_1
s_lshr_b32 s62, s81, 9
s_mul_i32 s62, s62, 50331648
s_add_u32 s63, s81, s93
s_and_b32 s63, s63, 511
s_mul_i32 s63, s63, 3072
s_add_u32 s62, s62, s63
s_cmp_ge_u32 s81, 1024
s_cselect_b32 s62, 0xf0000000, s62
v_add_u32 v2, s62, v3
buffer_load_dwordx4 v[84:87], v2, s[28:31], 0 offen offset:0 nt
buffer_load_dwordx4 v[88:91], v2, s[28:31], 0 offen offset:128 nt
buffer_load_dwordx4 v[92:95], v2, s[28:31], 0 offen offset:256 nt
buffer_load_dwordx4 v[96:99], v2, s[32:35], 0 offen offset:0 nt
buffer_load_dwordx4 v[100:103], v2, s[32:35], 0 offen offset:128 nt
buffer_load_dwordx4 v[104:107], v2, s[32:35], 0 offen offset:256 nt
L_rj_1:
s_branch L_loop
L_dma_0:
buffer_load_dwordx4 v254, s[52:55], s25 offen nt lds
s_add_u32 m0, m0, 1024
s_add_u32 s25, s25, 1280
buffer_load_dwordx4 v254, s[52:55], s25 offen nt lds
s_add_u32 m0, m0, 1024
s_add_u32 s25, s25, 1280
buffer_load_dwordx4 v254, s[52:55], s25 offen nt lds
s_add_u32 m0, m0, 1024
s_add_u32 s25, s25, 1280
buffer_load_dwordx4 v254, s[52:55], s25 offen nt lds
s_add_u32 m0, m0, 1024
s_add_u32 s25, s25, 1280
buffer_load_dwordx4 v254, s[52:55], s25 offen nt lds
s_add_u32 m0, m0, 1024
s_add_u32 s25, s25, 1280
buffer_load_dwordx4 v254, s[52:55], s25 offen nt lds
s_add_u32 m0, m0, 1024
s_add_u32 s25, s25, 1280
s_branch L_rj_0
L_dma_1:
buffer_load_dwordx4 v254, s[52:55], s25 offen nt lds
s_add_u32 m0, m0, 1024
s_add_u32 s25, s25, 1280
buffer_load_dwordx4 v254, s[52:55], s25 offen nt lds
s_add_u32 m0, m0, 1024
s_add_u32 s25, s25, 1280
buffer_load_dwordx4 v254, s[52:55], s25 offen nt lds
s_add_u32 m0, m0, 1024
s_add_u32 s25, s25, 1280
buffer_load_dwordx4 v254, s[52:55], s25 offen nt lds
s_add_u32 m0, m0, 1024
s_add_u32 s25, s25, 1280
buffer_load_dwordx4 v254, s[52:55], s25 offen nt lds
s_add_u32 m0, m0, 1024
s_add_u32 s25, s25, 1280
buffer_load_dwordx4 v254, s[52:55], s25 offen nt lds
s_add_u32 m0, m0, 1024
s_add_u32 s25, s25, 1280
s_branch L_rj_1
L_sw_0:
s_cmp_ge_u32 s80, 1024
s_cbranch_scc1 L_loopend
s_call_b64 s[84:85], L_switch
s_branch L_cont_0
L_sw_1:
s_cmp_ge_u32 s81, 1024
s_cbranch_scc1 L_loopend
s_call_b64 s[84:85], L_switch
s_branch L_cont_1
L_switch:
s_call_b64 s[22:23], L_flush
v_mov_b32 v20, 0
v_mov_b32 v21, 0
v_mov_b32 v22, 0
v_mov_b32 v23, 0
v_mov_b32 v24, 0
v_mov_b32 v25, 0
v_mov_b32 v26, 0
v_mov_b32 v27, 0
v_mov_b32 v28, 0
v_mov_b32 v29, 0
v_mov_b32 v30, 0
v_mov_b32 v31, 0
v_mov_b32 v32, 0
v_mov_b32 v33, 0
v_mov_b32 v34, 0
v_mov_b32 v35, 0
v_mov_b32 v36, 0
v_mov_b32 v37, 0
v_mov_b32 v38, 0
v_mov_b32 v39, 0
v_mov_b32 v40, 0
v_mov_b32 v41, 0
v_mov_b32 v42, 0
v_mov_b32 v43, 0
v_mov_b32 v44, 0xff000000
v_mov_b32 v45, 0
v_and_b32 v7, 7, v1
v_lshlrev_b32 v6, 4, v7
ds_read_b128 v[8:11], v6 offset:7040
ds_read_b128 v[12:15], v6 offset:7168
ds_read_b128 v[16:19], v6 offset:7296
s_mov_b32 s59, 1024
s_mov_b32 s21, 3072
s_waitcnt lgkmcnt(0)
s_setpc_b64 s[84:85]
L_flush:
v_mov_b32 v46, v44
v_add_u32 v6, s21, v236
s_lshl_b32 s62, s56, 3
s_lshr_b32 s63, s21, 6
s_and_b32 s63, s63, 32
s_add_u32 s62, s62, s63
v_max_f32_dpp v46, v46, v46 row_ror:8 row_mask:0xf bank_mask:0xf
v_mov_b32 v7, s62
v_mov_b32 v47, v46
s_nop 1
v_permlane16_swap_b32 v46, v47
v_max_f32 v46, v46, v47
v_mov_b32 v47, v46
s_nop 1
v_permlane32_swap_b32 v46, v47
v_max_f32 v46, v46, v47
v_sub_f32 v48, v44, v46
v_exp_f32 v48, v48
s_nop 0
v_mul_f32 v47, v45, v48
v_pk_mul_f32 v[20:21], v[20:21], v[48:49] op_sel_hi:[1,0]
v_pk_mul_f32 v[22:23], v[22:23], v[48:49] op_sel_hi:[1,0]
v_pk_mul_f32 v[24:25], v[24:25], v[48:49] op_sel_hi:[1,0]
v_pk_mul_f32 v[26:27], v[26:27], v[48:49] op_sel_hi:[1,0]
v_pk_mul_f32 v[28:29], v[28:29], v[48:49] op_sel_hi:[1,0]
v_pk_mul_f32 v[30:31], v[30:31], v[48:49] op_sel_hi:[1,0]
v_pk_mul_f32 v[32:33], v[32:33], v[48:49] op_sel_hi:[1,0]
v_pk_mul_f32 v[34:35], v[34:35], v[48:49] op_sel_hi:[1,0]
v_pk_mul_f32 v[36:37], v[36:37], v[48:49] op_sel_hi:[1,0]
v_pk_mul_f32 v[38:39], v[38:39], v[48:49] op_sel_hi:[1,0]
v_pk_mul_f32 v[40:41], v[40:41], v[48:49] op_sel_hi:[1,0]
v_pk_mul_f32 v[42:43], v[42:43], v[48:49] op_sel_hi:[1,0]
v_add_f32_dpp v47, v47, v47 row_ror:8 row_mask:0xf bank_mask:0xf
v_permlane32_swap_b32 v20, v24
v_permlane32_swap_b32 v21, v25
v_permlane32_swap_b32 v22, v26
v_permlane32_swap_b32 v23, v27
v_permlane32_swap_b32 v28, v32
v_permlane32_swap_b32 v29, v33
v_permlane32_swap_b32 v30, v34
v_permlane32_swap_b32 v31, v35
v_permlane32_swap_b32 v36, v40
v_permlane32_swap_b32 v37, v41
v_permlane32_swap_b32 v38, v42
v_permlane32_swap_b32 v39, v43
v_mov_b32 v49, v47
v_add_f32 v20, v20, v24
v_add_f32 v21, v21, v25
v_add_f32 v22, v22, v26
v_add_f32 v23, v23, v27
v_add_f32 v28, v28, v32
v_add_f32 v29, v29, v33
v_add_f32 v30, v30, v34
v_add_f32 v31, v31, v35
v_add_f32 v36, v36, v40
v_add_f32 v37, v37, v41
v_add_f32 v38, v38, v42
v_add_f32 v39, v39, v43
v_permlane16_swap_b32 v47, v49
v_permlane16_swap_b32 v20, v22
v_permlane16_swap_b32 v21, v23
v_permlane16_swap_b32 v28, v30
v_permlane16_swap_b32 v29, v31
v_permlane16_swap_b32 v36, v38
v_permlane16_swap_b32 v37, v39
v_add_f32 v47, v47, v49
v_add_f32 v20, v20, v22
v_add_f32 v21, v21, v23
v_add_f32 v28, v28, v30
v_add_f32 v29, v29, v31
v_add_f32 v36, v36, v38
v_add_f32 v37, v37, v39
v_mov_b32 v49, v47
v_add_f32_dpp v20, v20, v20 row_ror:8 row_mask:0xf bank_mask:0xf
v_add_f32_dpp v21, v21, v21 row_ror:8 row_mask:0xf bank_mask:0xf
v_add_f32_dpp v28, v28, v28 row_ror:8 row_mask:0xf bank_mask:0xf
v_add_f32_dpp v29, v29, v29 row_ror:8 row_mask:0xf bank_mask:0xf
v_add_f32_dpp v36, v36, v36 row_ror:8 row_mask:0xf bank_mask:0xf
v_add_f32_dpp v37, v37, v37 row_ror:8 row_mask:0xf bank_mask:0xf
v_permlane32_swap_b32 v47, v49
ds_write_b64 v6, v[20:21] offset:7424
ds_write_b64 v6, v[28:29] offset:7680
ds_write_b64 v6, v[36:37] offset:7936
v_add_f32 v47, v47, v49
ds_write_b64 v7, v[46:47] offset:13568
s_setpc_b64 s[22:23]
L_loopend:
L_dmafix:
s_cmp_ge_u32 s25, 15360
s_cbranch_scc1 L_dmafix_done
buffer_load_dwordx4 v254, s[52:55], s25 offen nt lds
s_add_u32 m0, m0, 1024
s_add_u32 s25, s25, 1280
s_branch L_dmafix
L_dmafix_done:
s_call_b64 s[22:23], L_flush
s_waitcnt lgkmcnt(0)
s_barrier
s_bitcmp1_b32 s56, 0
s_cselect_b32 exec_hi, 0, -1
ds_read_b64 v[20:21], v237 offset:7424
ds_read_b64 v[22:23], v237 offset:8192
ds_read_b64 v[24:25], v237 offset:8960
ds_read_b64 v[26:27], v237 offset:9728
ds_read_b128 v[28:31], v238 offset:13568
ds_read_b128 v[32:35], v238 offset:13584
s_mov_b32 vcc_lo, 0xaaaaaaaa
s_mov_b32 vcc_hi, 0xaaaaaaaa
v_mov_b32 v43, s60
s_waitcnt lgkmcnt(0)
v_max_f32 v36, v28, v30
v_max3_f32 v36, v36, v32, v34
v_sub_f32 v28, v28, v36
v_sub_f32 v30, v30, v36
v_sub_f32 v32, v32, v36
v_sub_f32 v34, v34, v36
v_exp_f32 v28, v28
v_exp_f32 v30, v30
v_exp_f32 v32, v32
v_exp_f32 v34, v34
v_mul_f32 v40, v20, v28
v_mul_f32 v41, v21, v28
v_mul_f32 v37, v29, v28
v_fmac_f32 v40, v22, v30
v_fmac_f32 v41, v23, v30
v_fmac_f32 v37, v31, v30
v_fmac_f32 v40, v24, v32
v_fmac_f32 v41, v25, v32
v_fmac_f32 v37, v33, v32
v_fmac_f32 v40, v26, v34
v_fmac_f32 v41, v27, v34
v_fmac_f32 v37, v35, v34
v_cndmask_b32 v42, v36, v37, vcc
buffer_store_dwordx4 v[40:43], v239, s[40:43], s13 offen sc0 sc1
L_pub_done:
s_mov_b64 exec, -1
s_cmp_lt_u32 s58, 3
s_cbranch_scc1 L_final
s_cmp_eq_u32 s56, 3
s_cbranch_scc1 L_wo_w3
s_mov_b32 s3, 1048576
L_p1s:
buffer_load_dwordx4 v[60:63], v250, s[40:43], s4 offen sc0 sc1
buffer_load_dwordx4 v[64:67], v250, s[40:43], s5 offen sc0 sc1
buffer_load_dwordx4 v[68:71], v250, s[40:43], s6 offen sc0 sc1
buffer_load_dwordx4 v[72:75], v250, s[40:43], s7 offen sc0 sc1
buffer_load_dwordx4 v[76:79], v250, s[40:43], s8 offen sc0 sc1
buffer_load_dwordx4 v[80:83], v250, s[40:43], s9 offen sc0 sc1
buffer_load_dwordx4 v[84:87], v250, s[40:43], s10 offen sc0 sc1
buffer_load_dwordx4 v[88:91], v250, s[40:43], s11 offen sc0 sc1
s_waitcnt vmcnt(0)
v_xor_b32 v52, s60, v63
v_bitop3_b32 v52, v52, v67, s60 bitop3:0xf6
v_bitop3_b32 v52, v52, v71, s60 bitop3:0xf6
v_bitop3_b32 v52, v52, v75, s60 bitop3:0xf6
v_bitop3_b32 v52, v52, v79, s60 bitop3:0xf6
v_bitop3_b32 v52, v52, v83, s60 bitop3:0xf6
v_bitop3_b32 v52, v52, v87, s60 bitop3:0xf6
v_bitop3_b32 v52, v52, v91, s60 bitop3:0xf6
v_cmp_ne_u32 vcc, 0, v52
s_mov_b64 exec, vcc
s_cbranch_execz L_p1s_done
s_sub_u32 s3, s3, 1
s_cmp_lg_u32 s3, 0
s_cbranch_scc1 L_p1s
L_p1s_done:
s_mov_b64 exec, -1
ds_read_b128 v[100:103], v252 offset:19968
ds_read_b128 v[104:107], v252 offset:20992
ds_read_b128 v[108:111], v252 offset:22016
ds_read_b128 v[112:115], v252 offset:23040
ds_read_b128 v[116:119], v252 offset:24064
ds_read_b128 v[120:123], v252 offset:25088
ds_read_b128 v[124:127], v252 offset:26112
ds_read_b128 v[128:131], v252 offset:27136
ds_read_b128 v[132:135], v252 offset:28160
ds_read_b128 v[136:139], v252 offset:29184
ds_read_b128 v[140:143], v252 offset:30208
ds_read_b128 v[144:147], v252 offset:31232
v_mov_b32_dpp v8, v62 quad_perm:[0,0,2,2] row_mask:0xf bank_mask:0xf
v_mov_b32_dpp v9, v66 quad_perm:[0,0,2,2] row_mask:0xf bank_mask:0xf
v_mov_b32_dpp v10, v70 quad_perm:[0,0,2,2] row_mask:0xf bank_mask:0xf
v_mov_b32_dpp v11, v74 quad_perm:[0,0,2,2] row_mask:0xf bank_mask:0xf
v_mov_b32_dpp v12, v78 quad_perm:[0,0,2,2] row_mask:0xf bank_mask:0xf
v_mov_b32_dpp v13, v82 quad_perm:[0,0,2,2] row_mask:0xf bank_mask:0xf
v_mov_b32_dpp v14, v86 quad_perm:[0,0,2,2] row_mask:0xf bank_mask:0xf
v_mov_b32_dpp v15, v90 quad_perm:[0,0,2,2] row_mask:0xf bank_mask:0xf
v_mov_b32_dpp v63, v62 quad_perm:[1,1,3,3] row_mask:0xf bank_mask:0xf
v_mov_b32_dpp v67, v66 quad_perm:[1,1,3,3] row_mask:0xf bank_mask:0xf
v_mov_b32_dpp v71, v70 quad_perm:[1,1,3,3] row_mask:0xf bank_mask:0xf
v_mov_b32_dpp v75, v74 quad_perm:[1,1,3,3] row_mask:0xf bank_mask:0xf
v_mov_b32_dpp v79, v78 quad_perm:[1,1,3,3] row_mask:0xf bank_mask:0xf
v_mov_b32_dpp v83, v82 quad_perm:[1,1,3,3] row_mask:0xf bank_mask:0xf
v_mov_b32_dpp v87, v86 quad_perm:[1,1,3,3] row_mask:0xf bank_mask:0xf
v_mov_b32_dpp v91, v90 quad_perm:[1,1,3,3] row_mask:0xf bank_mask:0xf
v_max3_f32 v36, v8, v9, v10
v_max3_f32 v37, v11, v12, v13
v_max3_f32 v36, v36, v14, v15
v_max_f32 v36, v36, v37
v_sub_f32 v8, v8, v36
v_sub_f32 v9, v9, v36
v_sub_f32 v10, v10, v36
v_sub_f32 v11, v11, v36
v_sub_f32 v12, v12, v36
v_sub_f32 v13, v13, v36
v_sub_f32 v14, v14, v36
v_sub_f32 v15, v15, v36
v_exp_f32 v8, v8
v_exp_f32 v9, v9
v_exp_f32 v10, v10
v_exp_f32 v11, v11
v_exp_f32 v12, v12
v_exp_f32 v13, v13
v_exp_f32 v14, v14
v_exp_f32 v15, v15
v_mul_f32 v40, v60, v8
v_mul_f32 v41, v61, v8
v_mul_f32 v37, v63, v8
v_fmac_f32 v37, v67, v9
v_fmac_f32 v40, v64, v9
v_fmac_f32 v41, v65, v9
v_fmac_f32 v37, v71, v10
v_fmac_f32 v40, v68, v10
v_fmac_f32 v41, v69, v10
v_fmac_f32 v37, v75, v11
v_fmac_f32 v40, v72, v11
v_fmac_f32 v41, v73, v11
v_fmac_f32 v37, v79, v12
v_fmac_f32 v40, v76, v12
v_fmac_f32 v41, v77, v12
v_fmac_f32 v37, v83, v13
v_fmac_f32 v40, v80, v13
v_fmac_f32 v41, v81, v13
v_fmac_f32 v37, v87, v14
v_fmac_f32 v40, v84, v14
v_fmac_f32 v41, v85, v14
v_fmac_f32 v37, v91, v15
v_fmac_f32 v40, v88, v15
v_fmac_f32 v41, v89, v15
v_rcp_f32 v37, v37
s_nop 0
v_mul_f32 v40, v40, v37
v_mul_f32 v41, v41, v37
v_cvt_pk_bf16_f32 v40, v40, v41
ds_write_b32 v251, v40 offset:13696
s_branch L_wo_bar
L_wo_w3:
s_waitcnt vmcnt(0)
ds_read_b128 v[100:103], v252 offset:19968
ds_read_b128 v[104:107], v252 offset:20992
ds_read_b128 v[108:111], v252 offset:22016
ds_read_b128 v[112:115], v252 offset:23040
ds_read_b128 v[116:119], v252 offset:24064
ds_read_b128 v[120:123], v252 offset:25088
ds_read_b128 v[124:127], v252 offset:26112
ds_read_b128 v[128:131], v252 offset:27136
ds_read_b128 v[132:135], v252 offset:28160
ds_read_b128 v[136:139], v252 offset:29184
ds_read_b128 v[140:143], v252 offset:30208
ds_read_b128 v[144:147], v252 offset:31232
L_wo_bar:
v_mov_b32 v20, 0
v_mov_b32 v21, 0
v_mov_b32 v22, 0
v_mov_b32 v23, 0
v_lshlrev_b32 v6, 3, v0
v_lshlrev_b32 v7, 4, v0
v_mov_b32 v41, s60
v_mov_b32 v43, s60
s_waitcnt lgkmcnt(0)
s_barrier
ds_read_b64 v[60:61], v248 offset:13696
ds_read_b64 v[62:63], v248 offset:13704
ds_read_b64 v[64:65], v248 offset:13712
s_waitcnt lgkmcnt(0)
v_perm_b32 v44, v60, v60, v240
v_perm_b32 v45, v60, v60, v241
v_perm_b32 v46, v60, v60, v242
v_perm_b32 v47, v60, v60, v243
v_perm_b32 v48, v60, v60, v244
v_perm_b32 v49, v60, v60, v245
v_perm_b32 v50, v60, v60, v246
v_perm_b32 v51, v60, v60, v247
v_mfma_f32_16x16x32_bf16 v[20:23], v[44:47], v[100:103], v[20:23]
v_perm_b32 v44, v61, v61, v240
v_perm_b32 v45, v61, v61, v241
v_perm_b32 v46, v61, v61, v242
v_perm_b32 v47, v61, v61, v243
v_mfma_f32_16x16x32_bf16 v[20:23], v[48:51], v[104:107], v[20:23]
v_perm_b32 v48, v61, v61, v244
v_perm_b32 v49, v61, v61, v245
v_perm_b32 v50, v61, v61, v246
v_perm_b32 v51, v61, v61, v247
v_mfma_f32_16x16x32_bf16 v[20:23], v[44:47], v[108:111], v[20:23]
v_perm_b32 v44, v62, v62, v240
v_perm_b32 v45, v62, v62, v241
v_perm_b32 v46, v62, v62, v242
v_perm_b32 v47, v62, v62, v243
v_mfma_f32_16x16x32_bf16 v[20:23], v[48:51], v[112:115], v[20:23]
v_perm_b32 v48, v62, v62, v244
v_perm_b32 v49, v62, v62, v245
v_perm_b32 v50, v62, v62, v246
v_perm_b32 v51, v62, v62, v247
v_mfma_f32_16x16x32_bf16 v[20:23], v[44:47], v[116:119], v[20:23]
v_perm_b32 v44, v63, v63, v240
v_perm_b32 v45, v63, v63, v241
v_perm_b32 v46, v63, v63, v242
v_perm_b32 v47, v63, v63, v243
v_mfma_f32_16x16x32_bf16 v[20:23], v[48:51], v[120:123], v[20:23]
v_perm_b32 v48, v63, v63, v244
v_perm_b32 v49, v63, v63, v245
v_perm_b32 v50, v63, v63, v246
v_perm_b32 v51, v63, v63, v247
v_mfma_f32_16x16x32_bf16 v[20:23], v[44:47], v[124:127], v[20:23]
v_perm_b32 v44, v64, v64, v240
v_perm_b32 v45, v64, v64, v241
v_perm_b32 v46, v64, v64, v242
v_perm_b32 v47, v64, v64, v243
v_mfma_f32_16x16x32_bf16 v[20:23], v[48:51], v[128:131], v[20:23]
v_perm_b32 v48, v64, v64, v244
v_perm_b32 v49, v64, v64, v245
v_perm_b32 v50, v64, v64, v246
v_perm_b32 v51, v64, v64, v247
v_mfma_f32_16x16x32_bf16 v[20:23], v[44:47], v[132:135], v[20:23]
v_perm_b32 v44, v65, v65, v240
v_perm_b32 v45, v65, v65, v241
v_perm_b32 v46, v65, v65, v242
v_perm_b32 v47, v65, v65, v243
v_mfma_f32_16x16x32_bf16 v[20:23], v[48:51], v[136:139], v[20:23]
v_perm_b32 v48, v65, v65, v244
v_perm_b32 v49, v65, v65, v245
v_perm_b32 v50, v65, v65, v246
v_perm_b32 v51, v65, v65, v247
v_mfma_f32_16x16x32_bf16 v[20:23], v[44:47], v[140:143], v[20:23]
s_nop 1
v_mfma_f32_16x16x32_bf16 v[20:23], v[48:51], v[144:147], v[20:23]
s_nop 7
ds_write_b128 v249, v[20:23] offset:14464
s_waitcnt lgkmcnt(0)
s_barrier
s_cmp_ge_u32 s56, 2
s_cbranch_scc1 L_fin
ds_read_b64 v[20:21], v6 offset:14464
ds_read_b64 v[22:23], v6 offset:15488
ds_read_b64 v[24:25], v6 offset:16512
ds_read_b64 v[26:27], v6 offset:17536
s_waitcnt lgkmcnt(0)
v_add_f32 v20, v20, v22
v_add_f32 v21, v21, v23
v_add_f32 v24, v24, v26
v_add_f32 v25, v25, v27
v_add_f32 v40, v20, v24
v_add_f32 v42, v21, v25
buffer_store_dwordx4 v[40:43], v7, s[40:43], s12 offen sc0 sc1
s_branch L_fin
L_final:
s_cmp_lg_u32 s56, 0
s_cbranch_scc1 L_fin
s_mul_i32 s14, s57, 3
s_add_u32 s14, s14, s58
s_cmp_ge_u32 s14, 40
s_cbranch_scc1 L_fin
s_cmp_ge_u32 s14, 20
s_cselect_b32 s15, 1, 0
s_mul_i32 s16, s15, 20
s_sub_u32 s16, s14, s16
s_lshr_b32 s17, s16, 2
s_and_b32 s18, s16, 3
s_mul_i32 s19, s15, 640
s_lshl_b32 s20, s16, 5
s_add_u32 s19, s19, s20
v_and_b32 v7, 7, v1
v_lshlrev_b32 v4, 2, v7
v_lshrrev_b32 v5, 5, v1
v_lshl_add_u32 v4, v5, 1, v4
v_bfe_u32 v5, v1, 4, 1
v_add_u32 v4, v4, v5
v_add_u32 v4, s19, v4
v_lshlrev_b32 v4, 1, v4
buffer_load_ushort v58, v4, s[44:47], 0 offen
v_lshrrev_b32 v5, 3, v1
v_mul_u32_u24 v6, 10240, v5
v_lshl_add_u32 v6, v7, 5, v6
s_lshl_b32 s20, s17, 11
s_lshl_b32 s21, s15, 10
s_add_u32 s20, s20, s21
s_lshl_b32 s21, s18, 8
s_add_u32 s20, s20, s21
s_add_u32 s20, s20, 1376256
s_lshl_b32 s21, s19, 3
s_add_u32 s21, s21, 1703936
s_add_u32 s5, s20, 81920
s_add_u32 s9, s21, 81920
s_add_u32 s6, s20, 163840
s_add_u32 s10, s21, 163840
s_add_u32 s7, s20, 245760
s_add_u32 s11, s21, 245760
s_mov_b32 s4, s20
s_mov_b32 s8, s21
s_mov_b32 s3, 1048576
L_pf:
buffer_load_dwordx4 v[100:103], v6, s[40:43], s8 offen sc0 sc1
buffer_load_dwordx4 v[104:107], v6, s[40:43], s8 offen offset:16 sc0 sc1
buffer_load_dwordx4 v[108:111], v6, s[40:43], s9 offen sc0 sc1
buffer_load_dwordx4 v[112:115], v6, s[40:43], s9 offen offset:16 sc0 sc1
buffer_load_dwordx4 v[116:119], v6, s[40:43], s10 offen sc0 sc1
buffer_load_dwordx4 v[120:123], v6, s[40:43], s10 offen offset:16 sc0 sc1
s_waitcnt vmcnt(0)
v_xor_b32 v52, s60, v101
v_bitop3_b32 v52, v52, v103, s60 bitop3:0xf6
v_bitop3_b32 v52, v52, v105, s60 bitop3:0xf6
v_bitop3_b32 v52, v52, v107, s60 bitop3:0xf6
v_bitop3_b32 v52, v52, v109, s60 bitop3:0xf6
v_bitop3_b32 v52, v52, v111, s60 bitop3:0xf6
v_bitop3_b32 v52, v52, v113, s60 bitop3:0xf6
v_bitop3_b32 v52, v52, v115, s60 bitop3:0xf6
v_bitop3_b32 v52, v52, v117, s60 bitop3:0xf6
v_bitop3_b32 v52, v52, v119, s60 bitop3:0xf6
v_bitop3_b32 v52, v52, v121, s60 bitop3:0xf6
v_bitop3_b32 v52, v52, v123, s60 bitop3:0xf6
v_cmp_ne_u32 vcc, 0, v52
s_mov_b64 exec, vcc
s_cbranch_execz L_pf_done
s_sub_u32 s3, s3, 1
s_cmp_lg_u32 s3, 0
s_cbranch_scc1 L_pf
L_pf_done:
s_mov_b64 exec, -1
v_add_f32 v100, v100, v108
v_add_f32 v102, v102, v110
v_add_f32 v104, v104, v112
v_add_f32 v106, v106, v114
v_add_f32 v100, v100, v116
v_add_f32 v102, v102, v118
v_add_f32 v104, v104, v120
v_add_f32 v106, v106, v122
s_nop 0
v_permlane32_swap_b32 v100, v104
v_permlane32_swap_b32 v102, v106
v_add_f32 v100, v100, v104
v_add_f32 v102, v102, v106
s_nop 1
v_permlane16_swap_b32 v100, v102
v_add_f32 v100, v100, v102
s_nop 1
v_add_f32_dpp v100, v100, v100 row_ror:8 row_mask:0xf bank_mask:0xf
s_mov_b32 s22, 0xbfb8aa3b
v_cvt_pk_bf16_f32 v24, v100, v100
v_and_b32 v24, 0xffff0000, v24
v_mul_f32 v25, s22, v24
v_exp_f32 v25, v25
s_nop 0
v_add_f32 v25, 1.0, v25
v_rcp_f32 v25, v25
s_nop 0
v_mul_f32 v24, v24, v25
v_cvt_pk_bf16_f32 v24, v24, v24
v_and_b32 v24, 0xffff0000, v24
v_lshlrev_b32 v58, 16, v58
s_mov_b32 s3, 1048576
L_p2:
buffer_load_dwordx4 v[60:63], v6, s[40:43], s4 offen sc0 sc1
buffer_load_dwordx4 v[64:67], v6, s[40:43], s4 offen offset:16 sc0 sc1
buffer_load_dwordx4 v[68:71], v6, s[40:43], s5 offen sc0 sc1
buffer_load_dwordx4 v[72:75], v6, s[40:43], s5 offen offset:16 sc0 sc1
buffer_load_dwordx4 v[76:79], v6, s[40:43], s6 offen sc0 sc1
buffer_load_dwordx4 v[80:83], v6, s[40:43], s6 offen offset:16 sc0 sc1
buffer_load_dwordx4 v[84:87], v6, s[40:43], s7 offen sc0 sc1
buffer_load_dwordx4 v[88:91], v6, s[40:43], s7 offen offset:16 sc0 sc1
s_waitcnt vmcnt(0)
v_xor_b32 v52, s60, v61
v_bitop3_b32 v52, v52, v63, s60 bitop3:0xf6
v_bitop3_b32 v52, v52, v65, s60 bitop3:0xf6
v_bitop3_b32 v52, v52, v67, s60 bitop3:0xf6
v_bitop3_b32 v52, v52, v69, s60 bitop3:0xf6
v_bitop3_b32 v52, v52, v71, s60 bitop3:0xf6
v_bitop3_b32 v52, v52, v73, s60 bitop3:0xf6
v_bitop3_b32 v52, v52, v75, s60 bitop3:0xf6
v_bitop3_b32 v52, v52, v77, s60 bitop3:0xf6
v_bitop3_b32 v52, v52, v79, s60 bitop3:0xf6
v_bitop3_b32 v52, v52, v81, s60 bitop3:0xf6
v_bitop3_b32 v52, v52, v83, s60 bitop3:0xf6
v_bitop3_b32 v52, v52, v85, s60 bitop3:0xf6
v_bitop3_b32 v52, v52, v87, s60 bitop3:0xf6
v_bitop3_b32 v52, v52, v89, s60 bitop3:0xf6
v_bitop3_b32 v52, v52, v91, s60 bitop3:0xf6
v_cmp_ne_u32 vcc, 0, v52
s_mov_b64 exec, vcc
s_cbranch_execz L_p2_done
s_sub_u32 s3, s3, 1
s_cmp_lg_u32 s3, 0
s_cbranch_scc1 L_p2
L_p2_done:
s_mov_b64 exec, -1
v_add_f32 v60, v60, v68
v_add_f32 v62, v62, v70
v_add_f32 v64, v64, v72
v_add_f32 v66, v66, v74
v_add_f32 v60, v60, v76
v_add_f32 v62, v62, v78
v_add_f32 v64, v64, v80
v_add_f32 v66, v66, v82
v_add_f32 v60, v60, v84
v_add_f32 v62, v62, v86
v_add_f32 v64, v64, v88
v_add_f32 v66, v66, v90
s_nop 0
v_permlane32_swap_b32 v60, v64
v_permlane32_swap_b32 v62, v66
v_add_f32 v60, v60, v64
v_add_f32 v62, v62, v66
s_nop 1
v_permlane16_swap_b32 v60, v62
v_add_f32 v60, v60, v62
s_nop 1
v_add_f32_dpp v60, v60, v60 row_ror:8 row_mask:0xf bank_mask:0xf
v_cvt_pk_bf16_f32 v20, v60, v60
v_and_b32 v20, 0xffff0000, v20
v_mul_f32 v20, v20, v24
v_cvt_pk_bf16_f32 v20, v20, v20
v_and_b32 v20, 0xffff0000, v20
v_add_f32 v20, v58, v20
v_cvt_pk_bf16_f32 v20, v20, v20
buffer_store_short v20, v4, s[48:51], 0 offen
s_cmp_lg_u32 s14, 0
s_cbranch_scc1 L_fin
s_mov_b64 exec, 1
v_mov_b32 v21, s60
v_mov_b32 v22, 0
buffer_store_dword v21, v22, s[40:43], 0 offen
s_branch L_fin
L_ffn:
s_setprio 3
s_sub_u32 s57, s2, 256
s_lshl_b32 s62, s57, 7
s_add_u32 s36, s16, s62
s_addc_u32 s37, s17, 0
s_mov_b32 s38, 1963136
s_mov_b32 s39, 0x20000
s_add_u32 s52, s18, s62
s_addc_u32 s53, s19, 0
s_mov_b32 s54, 1963136
s_mov_b32 s55, 0x20000
s_mul_i32 s62, s57, 81920
s_add_u32 s28, s20, s62
s_addc_u32 s29, s21, 0
s_mov_b32 s30, 81920
s_mov_b32 s31, 0x20000
v_mul_u32_u24 v4, 20, v1
buffer_load_dwordx4 v[8:11], v4, s[44:47], 0 offen
buffer_load_dword v12, v4, s[44:47], 0 offen offset:16
buffer_load_dwordx4 v[14:17], v4, s[44:47], 0 offen offset:1280
buffer_load_dword v18, v4, s[44:47], 0 offen offset:1296
v_lshrrev_b32 v6, 3, v1
v_mul_u32_u24 v6, 80, v6
s_mul_i32 s62, s56, 20
v_add_u32 v6, s62, v6
s_mov_b32 s62, 3072
v_mul_lo_u32 v6, v6, s62
v_and_b32 v7, 7, v1
v_lshl_add_u32 v2, v7, 4, v6
v_lshrrev_b32 v3, 4, v1
v_lshlrev_b32 v3, 2, v3
s_lshl_b32 s62, s56, 4
v_add_u32 v3, s62, v3
v_mul_u32_u24 v3, 1280, v3
v_and_b32 v7, 15, v1
v_lshl_add_u32 v3, v7, 4, v3
s_mov_b32 s63, 0
buffer_load_dwordx4 v[60:63], v2, s[36:39], s63 offen nt
s_mov_b32 s63, 3072
buffer_load_dwordx4 v[64:67], v2, s[36:39], s63 offen nt
s_mov_b32 s63, 6144
buffer_load_dwordx4 v[68:71], v2, s[36:39], s63 offen nt
s_mov_b32 s63, 9216
buffer_load_dwordx4 v[72:75], v2, s[36:39], s63 offen nt
s_mov_b32 s63, 12288
buffer_load_dwordx4 v[76:79], v2, s[36:39], s63 offen nt
s_mov_b32 s63, 15360
buffer_load_dwordx4 v[80:83], v2, s[36:39], s63 offen nt
s_mov_b32 s63, 18432
buffer_load_dwordx4 v[84:87], v2, s[36:39], s63 offen nt
s_mov_b32 s63, 21504
buffer_load_dwordx4 v[88:91], v2, s[36:39], s63 offen nt
s_mov_b32 s63, 24576
buffer_load_dwordx4 v[92:95], v2, s[36:39], s63 offen nt
s_mov_b32 s63, 27648
buffer_load_dwordx4 v[96:99], v2, s[36:39], s63 offen nt
s_mov_b32 s63, 30720
buffer_load_dwordx4 v[100:103], v2, s[36:39], s63 offen nt
s_mov_b32 s63, 33792
buffer_load_dwordx4 v[104:107], v2, s[36:39], s63 offen nt
s_mov_b32 s63, 36864
buffer_load_dwordx4 v[108:111], v2, s[36:39], s63 offen nt
s_mov_b32 s63, 39936
buffer_load_dwordx4 v[112:115], v2, s[36:39], s63 offen nt
s_mov_b32 s63, 43008
buffer_load_dwordx4 v[116:119], v2, s[36:39], s63 offen nt
s_mov_b32 s63, 46080
buffer_load_dwordx4 v[120:123], v2, s[36:39], s63 offen nt
s_waitcnt vmcnt(16)
v_lshlrev_b32 v20, 16, v8
v_and_b32 v21, 0xffff0000, v8
v_lshlrev_b32 v22, 16, v9
v_and_b32 v23, 0xffff0000, v9
v_lshlrev_b32 v24, 16, v10
v_and_b32 v25, 0xffff0000, v10
v_lshlrev_b32 v26, 16, v11
v_and_b32 v27, 0xffff0000, v11
v_lshlrev_b32 v28, 16, v12
v_and_b32 v29, 0xffff0000, v12
v_lshlrev_b32 v30, 16, v14
v_and_b32 v31, 0xffff0000, v14
v_lshlrev_b32 v32, 16, v15
v_and_b32 v33, 0xffff0000, v15
v_lshlrev_b32 v34, 16, v16
v_and_b32 v35, 0xffff0000, v16
v_lshlrev_b32 v36, 16, v17
v_and_b32 v37, 0xffff0000, v17
v_lshlrev_b32 v38, 16, v18
v_and_b32 v39, 0xffff0000, v18
v_add_f32 v40, v20, v21
v_add_f32 v41, v30, v31
v_add_f32 v40, v40, v22
v_add_f32 v41, v41, v32
v_add_f32 v40, v40, v23
v_add_f32 v41, v41, v33
v_add_f32 v40, v40, v24
v_add_f32 v41, v41, v34
v_add_f32 v40, v40, v25
v_add_f32 v41, v41, v35
v_add_f32 v40, v40, v26
v_add_f32 v41, v41, v36
v_add_f32 v40, v40, v27
v_add_f32 v41, v41, v37
v_add_f32 v40, v40, v28
v_add_f32 v41, v41, v38
v_add_f32 v40, v40, v29
v_add_f32 v41, v41, v39
s_nop 0
v_add_f32_dpp v40, v40, v40 quad_perm:[1,0,3,2] row_mask:0xf bank_mask:0xf
v_add_f32_dpp v41, v41, v41 quad_perm:[1,0,3,2] row_mask:0xf bank_mask:0xf
s_nop 0
v_add_f32_dpp v40, v40, v40 quad_perm:[2,3,0,1] row_mask:0xf bank_mask:0xf
v_add_f32_dpp v41, v41, v41 quad_perm:[2,3,0,1] row_mask:0xf bank_mask:0xf
s_nop 0
v_add_f32_dpp v40, v40, v40 row_half_mirror row_mask:0xf bank_mask:0xf
v_add_f32_dpp v41, v41, v41 row_half_mirror row_mask:0xf bank_mask:0xf
s_nop 0
v_add_f32_dpp v40, v40, v40 row_mirror row_mask:0xf bank_mask:0xf
v_add_f32_dpp v41, v41, v41 row_mirror row_mask:0xf bank_mask:0xf
v_mov_b32 v46, v40
v_mov_b32 v47, v41
s_nop 0
v_permlane16_swap_b32 v40, v46
v_permlane16_swap_b32 v41, v47
v_add_f32 v40, v40, v46
v_add_f32 v41, v41, v47
v_mov_b32 v46, v40
v_mov_b32 v47, v41
s_nop 0
v_permlane32_swap_b32 v40, v46
v_permlane32_swap_b32 v41, v47
v_add_f32 v40, v40, v46
v_add_f32 v41, v41, v47
s_mov_b32 s62, 0x3acccccd
v_mul_f32 v40, s62, v40
v_mul_f32 v41, s62, v41
v_sub_f32 v48, v20, v40
v_sub_f32 v49, v30, v41
v_mul_f32 v42, v48, v48
v_mul_f32 v43, v49, v49
v_sub_f32 v50, v21, v40
v_sub_f32 v51, v31, v41
v_fmac_f32 v42, v50, v50
v_fmac_f32 v43, v51, v51
v_sub_f32 v48, v22, v40
v_sub_f32 v49, v32, v41
v_fmac_f32 v42, v48, v48
v_fmac_f32 v43, v49, v49
v_sub_f32 v50, v23, v40
v_sub_f32 v51, v33, v41
v_fmac_f32 v42, v50, v50
v_fmac_f32 v43, v51, v51
v_sub_f32 v48, v24, v40
v_sub_f32 v49, v34, v41
v_fmac_f32 v42, v48, v48
v_fmac_f32 v43, v49, v49
v_sub_f32 v50, v25, v40
v_sub_f32 v51, v35, v41
v_fmac_f32 v42, v50, v50
v_fmac_f32 v43, v51, v51
v_sub_f32 v48, v26, v40
v_sub_f32 v49, v36, v41
v_fmac_f32 v42, v48, v48
v_fmac_f32 v43, v49, v49
v_sub_f32 v50, v27, v40
v_sub_f32 v51, v37, v41
v_fmac_f32 v42, v50, v50
v_fmac_f32 v43, v51, v51
v_sub_f32 v48, v28, v40
v_sub_f32 v49, v38, v41
v_fmac_f32 v42, v48, v48
v_fmac_f32 v43, v49, v49
v_sub_f32 v50, v29, v40
v_sub_f32 v51, v39, v41
v_fmac_f32 v42, v50, v50
v_fmac_f32 v43, v51, v51
s_nop 0
v_add_f32_dpp v42, v42, v42 quad_perm:[1,0,3,2] row_mask:0xf bank_mask:0xf
v_add_f32_dpp v43, v43, v43 quad_perm:[1,0,3,2] row_mask:0xf bank_mask:0xf
s_nop 0
v_add_f32_dpp v42, v42, v42 quad_perm:[2,3,0,1] row_mask:0xf bank_mask:0xf
v_add_f32_dpp v43, v43, v43 quad_perm:[2,3,0,1] row_mask:0xf bank_mask:0xf
s_nop 0
v_add_f32_dpp v42, v42, v42 row_half_mirror row_mask:0xf bank_mask:0xf
v_add_f32_dpp v43, v43, v43 row_half_mirror row_mask:0xf bank_mask:0xf
s_nop 0
v_add_f32_dpp v42, v42, v42 row_mirror row_mask:0xf bank_mask:0xf
v_add_f32_dpp v43, v43, v43 row_mirror row_mask:0xf bank_mask:0xf
v_mov_b32 v46, v42
v_mov_b32 v47, v43
s_nop 0
v_permlane16_swap_b32 v42, v46
v_permlane16_swap_b32 v43, v47
v_add_f32 v42, v42, v46
v_add_f32 v43, v43, v47
v_mov_b32 v46, v42
v_mov_b32 v47, v43
s_nop 0
v_permlane32_swap_b32 v42, v46
v_permlane32_swap_b32 v43, v47
v_add_f32 v42, v42, v46
v_add_f32 v43, v43, v47
v_mul_f32 v42, s62, v42
v_mul_f32 v43, s62, v43
v_cvt_pk_bf16_f32 v46, v40, v41
v_cvt_pk_bf16_f32 v47, v42, v43
v_lshlrev_b32 v40, 16, v46
v_and_b32 v41, 0xffff0000, v46
v_lshlrev_b32 v42, 16, v47
v_and_b32 v43, 0xffff0000, v47
v_add_f32 v42, 0x3727c5ac, v42
v_add_f32 v43, 0x3727c5ac, v43
v_cvt_pk_bf16_f32 v46, v42, v43
v_lshlrev_b32 v42, 16, v46
v_and_b32 v43, 0xffff0000, v46
v_sqrt_f32 v42, v42
v_sqrt_f32 v43, v43
s_nop 0
v_cvt_pk_bf16_f32 v46, v42, v43
v_lshlrev_b32 v42, 16, v46
v_and_b32 v43, 0xffff0000, v46
v_rcp_f32 v42, v42
v_rcp_f32 v43, v43
v_mul_u32_u24 v5, 20, v1
v_sub_f32 v20, v20, v40
v_sub_f32 v21, v21, v40
v_sub_f32 v30, v30, v41
v_sub_f32 v31, v31, v41
v_cvt_pk_bf16_f32 v46, v20, v21
v_cvt_pk_bf16_f32 v47, v30, v31
v_lshlrev_b32 v20, 16, v46
v_and_b32 v21, 0xffff0000, v46
v_lshlrev_b32 v30, 16, v47
v_and_b32 v31, 0xffff0000, v47
v_mul_f32 v20, v20, v42
v_mul_f32 v21, v21, v42
v_mul_f32 v30, v30, v43
v_mul_f32 v31, v31, v43
v_cvt_pk_bf16_f32 v20, v20, v21
v_cvt_pk_bf16_f32 v30, v30, v31
ds_write_b32 v5, v20 offset:0
ds_write_b32 v5, v30 offset:1280
v_sub_f32 v22, v22, v40
v_sub_f32 v23, v23, v40
v_sub_f32 v32, v32, v41
v_sub_f32 v33, v33, v41
v_cvt_pk_bf16_f32 v46, v22, v23
v_cvt_pk_bf16_f32 v47, v32, v33
v_lshlrev_b32 v22, 16, v46
v_and_b32 v23, 0xffff0000, v46
v_lshlrev_b32 v32, 16, v47
v_and_b32 v33, 0xffff0000, v47
v_mul_f32 v22, v22, v42
v_mul_f32 v23, v23, v42
v_mul_f32 v32, v32, v43
v_mul_f32 v33, v33, v43
v_cvt_pk_bf16_f32 v22, v22, v23
v_cvt_pk_bf16_f32 v32, v32, v33
ds_write_b32 v5, v22 offset:4
ds_write_b32 v5, v32 offset:1284
v_sub_f32 v24, v24, v40
v_sub_f32 v25, v25, v40
v_sub_f32 v34, v34, v41
v_sub_f32 v35, v35, v41
v_cvt_pk_bf16_f32 v46, v24, v25
v_cvt_pk_bf16_f32 v47, v34, v35
v_lshlrev_b32 v24, 16, v46
v_and_b32 v25, 0xffff0000, v46
v_lshlrev_b32 v34, 16, v47
v_and_b32 v35, 0xffff0000, v47
v_mul_f32 v24, v24, v42
v_mul_f32 v25, v25, v42
v_mul_f32 v34, v34, v43
v_mul_f32 v35, v35, v43
v_cvt_pk_bf16_f32 v24, v24, v25
v_cvt_pk_bf16_f32 v34, v34, v35
ds_write_b32 v5, v24 offset:8
ds_write_b32 v5, v34 offset:1288
v_sub_f32 v26, v26, v40
v_sub_f32 v27, v27, v40
v_sub_f32 v36, v36, v41
v_sub_f32 v37, v37, v41
v_cvt_pk_bf16_f32 v46, v26, v27
v_cvt_pk_bf16_f32 v47, v36, v37
v_lshlrev_b32 v26, 16, v46
v_and_b32 v27, 0xffff0000, v46
v_lshlrev_b32 v36, 16, v47
v_and_b32 v37, 0xffff0000, v47
v_mul_f32 v26, v26, v42
v_mul_f32 v27, v27, v42
v_mul_f32 v36, v36, v43
v_mul_f32 v37, v37, v43
v_cvt_pk_bf16_f32 v26, v26, v27
v_cvt_pk_bf16_f32 v36, v36, v37
ds_write_b32 v5, v26 offset:12
ds_write_b32 v5, v36 offset:1292
v_sub_f32 v28, v28, v40
v_sub_f32 v29, v29, v40
v_sub_f32 v38, v38, v41
v_sub_f32 v39, v39, v41
v_cvt_pk_bf16_f32 v46, v28, v29
v_cvt_pk_bf16_f32 v47, v38, v39
v_lshlrev_b32 v28, 16, v46
v_and_b32 v29, 0xffff0000, v46
v_lshlrev_b32 v38, 16, v47
v_and_b32 v39, 0xffff0000, v47
v_mul_f32 v28, v28, v42
v_mul_f32 v29, v29, v42
v_mul_f32 v38, v38, v43
v_mul_f32 v39, v39, v43
v_cvt_pk_bf16_f32 v28, v28, v29
v_cvt_pk_bf16_f32 v38, v38, v39
ds_write_b32 v5, v28 offset:16
ds_write_b32 v5, v38 offset:1296
v_lshrrev_b32 v6, 3, v1
v_mul_u32_u24 v6, 160, v6
s_mul_i32 s62, s56, 40
v_add_u32 v6, s62, v6
s_waitcnt lgkmcnt(0)
ds_read_b32 v236, v6 offset:0
ds_read_b32 v237, v6 offset:4
ds_read_b32 v238, v6 offset:8
ds_read_b32 v239, v6 offset:12
ds_read_b32 v240, v6 offset:16
ds_read_b32 v241, v6 offset:20
ds_read_b32 v242, v6 offset:24
ds_read_b32 v243, v6 offset:28
ds_read_b32 v244, v6 offset:32
ds_read_b32 v245, v6 offset:36
ds_read_b32 v246, v6 offset:1280
ds_read_b32 v247, v6 offset:1284
ds_read_b32 v248, v6 offset:1288
ds_read_b32 v249, v6 offset:1292
ds_read_b32 v250, v6 offset:1296
ds_read_b32 v251, v6 offset:1300
ds_read_b32 v252, v6 offset:1304
ds_read_b32 v253, v6 offset:1308
ds_read_b32 v254, v6 offset:1312
ds_read_b32 v255, v6 offset:1316
v_mov_b32 v20, 0
v_mov_b32 v21, 0
v_mov_b32 v22, 0
v_mov_b32 v23, 0
v_mov_b32 v24, 0
v_mov_b32 v25, 0
v_mov_b32 v26, 0
v_mov_b32 v27, 0
v_mov_b32 v28, 0
v_mov_b32 v29, 0
v_mov_b32 v30, 0
v_mov_b32 v31, 0
v_mov_b32 v32, 0
v_mov_b32 v33, 0
v_mov_b32 v34, 0
v_mov_b32 v35, 0
v_mov_b32 v36, 0
v_mov_b32 v37, 0
v_mov_b32 v38, 0
v_mov_b32 v39, 0
v_mov_b32 v40, 0
v_mov_b32 v41, 0
v_mov_b32 v42, 0
v_mov_b32 v43, 0
v_mov_b32 v44, 0
v_mov_b32 v45, 0
v_mov_b32 v46, 0
v_mov_b32 v47, 0
v_mov_b32 v48, 0
v_mov_b32 v49, 0
v_mov_b32 v50, 0
v_mov_b32 v51, 0
s_waitcnt lgkmcnt(0)
s_waitcnt vmcnt(15)
v_and_b32 v52, 0xffff, v236
v_lshlrev_b32 v53, 16, v236
v_and_b32 v54, 0xffff, v246
v_lshlrev_b32 v55, 16, v246
v_dot2c_f32_bf16 v20, v60, v52
v_dot2c_f32_bf16 v21, v60, v53
v_dot2c_f32_bf16 v28, v60, v54
v_dot2c_f32_bf16 v29, v60, v55
v_dot2c_f32_bf16 v22, v61, v52
v_dot2c_f32_bf16 v23, v61, v53
v_dot2c_f32_bf16 v30, v61, v54
v_dot2c_f32_bf16 v31, v61, v55
v_dot2c_f32_bf16 v24, v62, v52
v_dot2c_f32_bf16 v25, v62, v53
v_dot2c_f32_bf16 v32, v62, v54
v_dot2c_f32_bf16 v33, v62, v55
v_dot2c_f32_bf16 v26, v63, v52
v_dot2c_f32_bf16 v27, v63, v53
v_dot2c_f32_bf16 v34, v63, v54
v_dot2c_f32_bf16 v35, v63, v55
s_mov_b32 s63, 49152
buffer_load_dwordx4 v[124:127], v2, s[36:39], s63 offen nt
s_waitcnt vmcnt(15)
v_lshrrev_b32 v52, 16, v236
v_and_b32 v53, 0xffff0000, v236
v_lshrrev_b32 v54, 16, v246
v_and_b32 v55, 0xffff0000, v246
v_dot2c_f32_bf16 v20, v64, v52
v_dot2c_f32_bf16 v21, v64, v53
v_dot2c_f32_bf16 v28, v64, v54
v_dot2c_f32_bf16 v29, v64, v55
v_dot2c_f32_bf16 v22, v65, v52
v_dot2c_f32_bf16 v23, v65, v53
v_dot2c_f32_bf16 v30, v65, v54
v_dot2c_f32_bf16 v31, v65, v55
v_dot2c_f32_bf16 v24, v66, v52
v_dot2c_f32_bf16 v25, v66, v53
v_dot2c_f32_bf16 v32, v66, v54
v_dot2c_f32_bf16 v33, v66, v55
v_dot2c_f32_bf16 v26, v67, v52
v_dot2c_f32_bf16 v27, v67, v53
v_dot2c_f32_bf16 v34, v67, v54
v_dot2c_f32_bf16 v35, v67, v55
s_mov_b32 s63, 52224
buffer_load_dwordx4 v[128:131], v2, s[36:39], s63 offen nt
s_waitcnt vmcnt(15)
v_and_b32 v52, 0xffff, v237
v_lshlrev_b32 v53, 16, v237
v_and_b32 v54, 0xffff, v247
v_lshlrev_b32 v55, 16, v247
v_dot2c_f32_bf16 v20, v68, v52
v_dot2c_f32_bf16 v21, v68, v53
v_dot2c_f32_bf16 v28, v68, v54
v_dot2c_f32_bf16 v29, v68, v55
v_dot2c_f32_bf16 v22, v69, v52
v_dot2c_f32_bf16 v23, v69, v53
v_dot2c_f32_bf16 v30, v69, v54
v_dot2c_f32_bf16 v31, v69, v55
v_dot2c_f32_bf16 v24, v70, v52
v_dot2c_f32_bf16 v25, v70, v53
v_dot2c_f32_bf16 v32, v70, v54
v_dot2c_f32_bf16 v33, v70, v55
v_dot2c_f32_bf16 v26, v71, v52
v_dot2c_f32_bf16 v27, v71, v53
v_dot2c_f32_bf16 v34, v71, v54
v_dot2c_f32_bf16 v35, v71, v55
s_mov_b32 s63, 55296
buffer_load_dwordx4 v[132:135], v2, s[36:39], s63 offen nt
s_waitcnt vmcnt(15)
v_lshrrev_b32 v52, 16, v237
v_and_b32 v53, 0xffff0000, v237
v_lshrrev_b32 v54, 16, v247
v_and_b32 v55, 0xffff0000, v247
v_dot2c_f32_bf16 v20, v72, v52
v_dot2c_f32_bf16 v21, v72, v53
v_dot2c_f32_bf16 v28, v72, v54
v_dot2c_f32_bf16 v29, v72, v55
v_dot2c_f32_bf16 v22, v73, v52
v_dot2c_f32_bf16 v23, v73, v53
v_dot2c_f32_bf16 v30, v73, v54
v_dot2c_f32_bf16 v31, v73, v55
v_dot2c_f32_bf16 v24, v74, v52
v_dot2c_f32_bf16 v25, v74, v53
v_dot2c_f32_bf16 v32, v74, v54
v_dot2c_f32_bf16 v33, v74, v55
v_dot2c_f32_bf16 v26, v75, v52
v_dot2c_f32_bf16 v27, v75, v53
v_dot2c_f32_bf16 v34, v75, v54
v_dot2c_f32_bf16 v35, v75, v55
s_mov_b32 s63, 58368
buffer_load_dwordx4 v[136:139], v2, s[36:39], s63 offen nt
s_waitcnt vmcnt(15)
v_and_b32 v52, 0xffff, v238
v_lshlrev_b32 v53, 16, v238
v_and_b32 v54, 0xffff, v248
v_lshlrev_b32 v55, 16, v248
v_dot2c_f32_bf16 v20, v76, v52
v_dot2c_f32_bf16 v21, v76, v53
v_dot2c_f32_bf16 v28, v76, v54
v_dot2c_f32_bf16 v29, v76, v55
v_dot2c_f32_bf16 v22, v77, v52
v_dot2c_f32_bf16 v23, v77, v53
v_dot2c_f32_bf16 v30, v77, v54
v_dot2c_f32_bf16 v31, v77, v55
v_dot2c_f32_bf16 v24, v78, v52
v_dot2c_f32_bf16 v25, v78, v53
v_dot2c_f32_bf16 v32, v78, v54
v_dot2c_f32_bf16 v33, v78, v55
v_dot2c_f32_bf16 v26, v79, v52
v_dot2c_f32_bf16 v27, v79, v53
v_dot2c_f32_bf16 v34, v79, v54
v_dot2c_f32_bf16 v35, v79, v55
s_mov_b32 s63, 0
buffer_load_dwordx4 v[140:143], v2, s[52:55], s63 offen nt
s_waitcnt vmcnt(15)
v_lshrrev_b32 v52, 16, v238
v_and_b32 v53, 0xffff0000, v238
v_lshrrev_b32 v54, 16, v248
v_and_b32 v55, 0xffff0000, v248
v_dot2c_f32_bf16 v20, v80, v52
v_dot2c_f32_bf16 v21, v80, v53
v_dot2c_f32_bf16 v28, v80, v54
v_dot2c_f32_bf16 v29, v80, v55
v_dot2c_f32_bf16 v22, v81, v52
v_dot2c_f32_bf16 v23, v81, v53
v_dot2c_f32_bf16 v30, v81, v54
v_dot2c_f32_bf16 v31, v81, v55
v_dot2c_f32_bf16 v24, v82, v52
v_dot2c_f32_bf16 v25, v82, v53
v_dot2c_f32_bf16 v32, v82, v54
v_dot2c_f32_bf16 v33, v82, v55
v_dot2c_f32_bf16 v26, v83, v52
v_dot2c_f32_bf16 v27, v83, v53
v_dot2c_f32_bf16 v34, v83, v54
v_dot2c_f32_bf16 v35, v83, v55
s_mov_b32 s63, 3072
buffer_load_dwordx4 v[144:147], v2, s[52:55], s63 offen nt
s_waitcnt vmcnt(15)
v_and_b32 v52, 0xffff, v239
v_lshlrev_b32 v53, 16, v239
v_and_b32 v54, 0xffff, v249
v_lshlrev_b32 v55, 16, v249
v_dot2c_f32_bf16 v20, v84, v52
v_dot2c_f32_bf16 v21, v84, v53
v_dot2c_f32_bf16 v28, v84, v54
v_dot2c_f32_bf16 v29, v84, v55
v_dot2c_f32_bf16 v22, v85, v52
v_dot2c_f32_bf16 v23, v85, v53
v_dot2c_f32_bf16 v30, v85, v54
v_dot2c_f32_bf16 v31, v85, v55
v_dot2c_f32_bf16 v24, v86, v52
v_dot2c_f32_bf16 v25, v86, v53
v_dot2c_f32_bf16 v32, v86, v54
v_dot2c_f32_bf16 v33, v86, v55
v_dot2c_f32_bf16 v26, v87, v52
v_dot2c_f32_bf16 v27, v87, v53
v_dot2c_f32_bf16 v34, v87, v54
v_dot2c_f32_bf16 v35, v87, v55
s_mov_b32 s63, 6144
buffer_load_dwordx4 v[148:151], v2, s[52:55], s63 offen nt
s_waitcnt vmcnt(15)
v_lshrrev_b32 v52, 16, v239
v_and_b32 v53, 0xffff0000, v239
v_lshrrev_b32 v54, 16, v249
v_and_b32 v55, 0xffff0000, v249
v_dot2c_f32_bf16 v20, v88, v52
v_dot2c_f32_bf16 v21, v88, v53
v_dot2c_f32_bf16 v28, v88, v54
v_dot2c_f32_bf16 v29, v88, v55
v_dot2c_f32_bf16 v22, v89, v52
v_dot2c_f32_bf16 v23, v89, v53
v_dot2c_f32_bf16 v30, v89, v54
v_dot2c_f32_bf16 v31, v89, v55
v_dot2c_f32_bf16 v24, v90, v52
v_dot2c_f32_bf16 v25, v90, v53
v_dot2c_f32_bf16 v32, v90, v54
v_dot2c_f32_bf16 v33, v90, v55
v_dot2c_f32_bf16 v26, v91, v52
v_dot2c_f32_bf16 v27, v91, v53
v_dot2c_f32_bf16 v34, v91, v54
v_dot2c_f32_bf16 v35, v91, v55
s_mov_b32 s63, 9216
buffer_load_dwordx4 v[152:155], v2, s[52:55], s63 offen nt
s_waitcnt vmcnt(15)
v_and_b32 v52, 0xffff, v240
v_lshlrev_b32 v53, 16, v240
v_and_b32 v54, 0xffff, v250
v_lshlrev_b32 v55, 16, v250
v_dot2c_f32_bf16 v20, v92, v52
v_dot2c_f32_bf16 v21, v92, v53
v_dot2c_f32_bf16 v28, v92, v54
v_dot2c_f32_bf16 v29, v92, v55
v_dot2c_f32_bf16 v22, v93, v52
v_dot2c_f32_bf16 v23, v93, v53
v_dot2c_f32_bf16 v30, v93, v54
v_dot2c_f32_bf16 v31, v93, v55
v_dot2c_f32_bf16 v24, v94, v52
v_dot2c_f32_bf16 v25, v94, v53
v_dot2c_f32_bf16 v32, v94, v54
v_dot2c_f32_bf16 v33, v94, v55
v_dot2c_f32_bf16 v26, v95, v52
v_dot2c_f32_bf16 v27, v95, v53
v_dot2c_f32_bf16 v34, v95, v54
v_dot2c_f32_bf16 v35, v95, v55
s_mov_b32 s63, 12288
buffer_load_dwordx4 v[156:159], v2, s[52:55], s63 offen nt
s_waitcnt vmcnt(15)
v_lshrrev_b32 v52, 16, v240
v_and_b32 v53, 0xffff0000, v240
v_lshrrev_b32 v54, 16, v250
v_and_b32 v55, 0xffff0000, v250
v_dot2c_f32_bf16 v20, v96, v52
v_dot2c_f32_bf16 v21, v96, v53
v_dot2c_f32_bf16 v28, v96, v54
v_dot2c_f32_bf16 v29, v96, v55
v_dot2c_f32_bf16 v22, v97, v52
v_dot2c_f32_bf16 v23, v97, v53
v_dot2c_f32_bf16 v30, v97, v54
v_dot2c_f32_bf16 v31, v97, v55
v_dot2c_f32_bf16 v24, v98, v52
v_dot2c_f32_bf16 v25, v98, v53
v_dot2c_f32_bf16 v32, v98, v54
v_dot2c_f32_bf16 v33, v98, v55
v_dot2c_f32_bf16 v26, v99, v52
v_dot2c_f32_bf16 v27, v99, v53
v_dot2c_f32_bf16 v34, v99, v54
v_dot2c_f32_bf16 v35, v99, v55
s_mov_b32 s63, 15360
buffer_load_dwordx4 v[160:163], v2, s[52:55], s63 offen nt
s_waitcnt vmcnt(15)
v_and_b32 v52, 0xffff, v241
v_lshlrev_b32 v53, 16, v241
v_and_b32 v54, 0xffff, v251
v_lshlrev_b32 v55, 16, v251
v_dot2c_f32_bf16 v20, v100, v52
v_dot2c_f32_bf16 v21, v100, v53
v_dot2c_f32_bf16 v28, v100, v54
v_dot2c_f32_bf16 v29, v100, v55
v_dot2c_f32_bf16 v22, v101, v52
v_dot2c_f32_bf16 v23, v101, v53
v_dot2c_f32_bf16 v30, v101, v54
v_dot2c_f32_bf16 v31, v101, v55
v_dot2c_f32_bf16 v24, v102, v52
v_dot2c_f32_bf16 v25, v102, v53
v_dot2c_f32_bf16 v32, v102, v54
v_dot2c_f32_bf16 v33, v102, v55
v_dot2c_f32_bf16 v26, v103, v52
v_dot2c_f32_bf16 v27, v103, v53
v_dot2c_f32_bf16 v34, v103, v54
v_dot2c_f32_bf16 v35, v103, v55
s_mov_b32 s63, 18432
buffer_load_dwordx4 v[164:167], v2, s[52:55], s63 offen nt
s_waitcnt vmcnt(15)
v_lshrrev_b32 v52, 16, v241
v_and_b32 v53, 0xffff0000, v241
v_lshrrev_b32 v54, 16, v251
v_and_b32 v55, 0xffff0000, v251
v_dot2c_f32_bf16 v20, v104, v52
v_dot2c_f32_bf16 v21, v104, v53
v_dot2c_f32_bf16 v28, v104, v54
v_dot2c_f32_bf16 v29, v104, v55
v_dot2c_f32_bf16 v22, v105, v52
v_dot2c_f32_bf16 v23, v105, v53
v_dot2c_f32_bf16 v30, v105, v54
v_dot2c_f32_bf16 v31, v105, v55
v_dot2c_f32_bf16 v24, v106, v52
v_dot2c_f32_bf16 v25, v106, v53
v_dot2c_f32_bf16 v32, v106, v54
v_dot2c_f32_bf16 v33, v106, v55
v_dot2c_f32_bf16 v26, v107, v52
v_dot2c_f32_bf16 v27, v107, v53
v_dot2c_f32_bf16 v34, v107, v54
v_dot2c_f32_bf16 v35, v107, v55
s_mov_b32 s63, 21504
buffer_load_dwordx4 v[168:171], v2, s[52:55], s63 offen nt
s_waitcnt vmcnt(15)
v_and_b32 v52, 0xffff, v242
v_lshlrev_b32 v53, 16, v242
v_and_b32 v54, 0xffff, v252
v_lshlrev_b32 v55, 16, v252
v_dot2c_f32_bf16 v20, v108, v52
v_dot2c_f32_bf16 v21, v108, v53
v_dot2c_f32_bf16 v28, v108, v54
v_dot2c_f32_bf16 v29, v108, v55
v_dot2c_f32_bf16 v22, v109, v52
v_dot2c_f32_bf16 v23, v109, v53
v_dot2c_f32_bf16 v30, v109, v54
v_dot2c_f32_bf16 v31, v109, v55
v_dot2c_f32_bf16 v24, v110, v52
v_dot2c_f32_bf16 v25, v110, v53
v_dot2c_f32_bf16 v32, v110, v54
v_dot2c_f32_bf16 v33, v110, v55
v_dot2c_f32_bf16 v26, v111, v52
v_dot2c_f32_bf16 v27, v111, v53
v_dot2c_f32_bf16 v34, v111, v54
v_dot2c_f32_bf16 v35, v111, v55
s_mov_b32 s63, 24576
buffer_load_dwordx4 v[172:175], v2, s[52:55], s63 offen nt
s_waitcnt vmcnt(15)
v_lshrrev_b32 v52, 16, v242
v_and_b32 v53, 0xffff0000, v242
v_lshrrev_b32 v54, 16, v252
v_and_b32 v55, 0xffff0000, v252
v_dot2c_f32_bf16 v20, v112, v52
v_dot2c_f32_bf16 v21, v112, v53
v_dot2c_f32_bf16 v28, v112, v54
v_dot2c_f32_bf16 v29, v112, v55
v_dot2c_f32_bf16 v22, v113, v52
v_dot2c_f32_bf16 v23, v113, v53
v_dot2c_f32_bf16 v30, v113, v54
v_dot2c_f32_bf16 v31, v113, v55
v_dot2c_f32_bf16 v24, v114, v52
v_dot2c_f32_bf16 v25, v114, v53
v_dot2c_f32_bf16 v32, v114, v54
v_dot2c_f32_bf16 v33, v114, v55
v_dot2c_f32_bf16 v26, v115, v52
v_dot2c_f32_bf16 v27, v115, v53
v_dot2c_f32_bf16 v34, v115, v54
v_dot2c_f32_bf16 v35, v115, v55
s_mov_b32 s63, 27648
buffer_load_dwordx4 v[176:179], v2, s[52:55], s63 offen nt
s_waitcnt vmcnt(15)
v_and_b32 v52, 0xffff, v243
v_lshlrev_b32 v53, 16, v243
v_and_b32 v54, 0xffff, v253
v_lshlrev_b32 v55, 16, v253
v_dot2c_f32_bf16 v20, v116, v52
v_dot2c_f32_bf16 v21, v116, v53
v_dot2c_f32_bf16 v28, v116, v54
v_dot2c_f32_bf16 v29, v116, v55
v_dot2c_f32_bf16 v22, v117, v52
v_dot2c_f32_bf16 v23, v117, v53
v_dot2c_f32_bf16 v30, v117, v54
v_dot2c_f32_bf16 v31, v117, v55
v_dot2c_f32_bf16 v24, v118, v52
v_dot2c_f32_bf16 v25, v118, v53
v_dot2c_f32_bf16 v32, v118, v54
v_dot2c_f32_bf16 v33, v118, v55
v_dot2c_f32_bf16 v26, v119, v52
v_dot2c_f32_bf16 v27, v119, v53
v_dot2c_f32_bf16 v34, v119, v54
v_dot2c_f32_bf16 v35, v119, v55
s_mov_b32 s63, 30720
buffer_load_dwordx4 v[180:183], v2, s[52:55], s63 offen nt
s_waitcnt vmcnt(15)
v_lshrrev_b32 v52, 16, v243
v_and_b32 v53, 0xffff0000, v243
v_lshrrev_b32 v54, 16, v253
v_and_b32 v55, 0xffff0000, v253
v_dot2c_f32_bf16 v20, v120, v52
v_dot2c_f32_bf16 v21, v120, v53
v_dot2c_f32_bf16 v28, v120, v54
v_dot2c_f32_bf16 v29, v120, v55
v_dot2c_f32_bf16 v22, v121, v52
v_dot2c_f32_bf16 v23, v121, v53
v_dot2c_f32_bf16 v30, v121, v54
v_dot2c_f32_bf16 v31, v121, v55
v_dot2c_f32_bf16 v24, v122, v52
v_dot2c_f32_bf16 v25, v122, v53
v_dot2c_f32_bf16 v32, v122, v54
v_dot2c_f32_bf16 v33, v122, v55
v_dot2c_f32_bf16 v26, v123, v52
v_dot2c_f32_bf16 v27, v123, v53
v_dot2c_f32_bf16 v34, v123, v54
v_dot2c_f32_bf16 v35, v123, v55
s_mov_b32 s63, 33792
buffer_load_dwordx4 v[184:187], v2, s[52:55], s63 offen nt
s_waitcnt vmcnt(15)
v_and_b32 v52, 0xffff, v244
v_lshlrev_b32 v53, 16, v244
v_and_b32 v54, 0xffff, v254
v_lshlrev_b32 v55, 16, v254
v_dot2c_f32_bf16 v20, v124, v52
v_dot2c_f32_bf16 v21, v124, v53
v_dot2c_f32_bf16 v28, v124, v54
v_dot2c_f32_bf16 v29, v124, v55
v_dot2c_f32_bf16 v22, v125, v52
v_dot2c_f32_bf16 v23, v125, v53
v_dot2c_f32_bf16 v30, v125, v54
v_dot2c_f32_bf16 v31, v125, v55
v_dot2c_f32_bf16 v24, v126, v52
v_dot2c_f32_bf16 v25, v126, v53
v_dot2c_f32_bf16 v32, v126, v54
v_dot2c_f32_bf16 v33, v126, v55
v_dot2c_f32_bf16 v26, v127, v52
v_dot2c_f32_bf16 v27, v127, v53
v_dot2c_f32_bf16 v34, v127, v54
v_dot2c_f32_bf16 v35, v127, v55
s_mov_b32 s63, 36864
buffer_load_dwordx4 v[188:191], v2, s[52:55], s63 offen nt
s_waitcnt vmcnt(15)
v_lshrrev_b32 v52, 16, v244
v_and_b32 v53, 0xffff0000, v244
v_lshrrev_b32 v54, 16, v254
v_and_b32 v55, 0xffff0000, v254
v_dot2c_f32_bf16 v20, v128, v52
v_dot2c_f32_bf16 v21, v128, v53
v_dot2c_f32_bf16 v28, v128, v54
v_dot2c_f32_bf16 v29, v128, v55
v_dot2c_f32_bf16 v22, v129, v52
v_dot2c_f32_bf16 v23, v129, v53
v_dot2c_f32_bf16 v30, v129, v54
v_dot2c_f32_bf16 v31, v129, v55
v_dot2c_f32_bf16 v24, v130, v52
v_dot2c_f32_bf16 v25, v130, v53
v_dot2c_f32_bf16 v32, v130, v54
v_dot2c_f32_bf16 v33, v130, v55
v_dot2c_f32_bf16 v26, v131, v52
v_dot2c_f32_bf16 v27, v131, v53
v_dot2c_f32_bf16 v34, v131, v54
v_dot2c_f32_bf16 v35, v131, v55
s_mov_b32 s63, 39936
buffer_load_dwordx4 v[192:195], v2, s[52:55], s63 offen nt
s_waitcnt vmcnt(15)
v_and_b32 v52, 0xffff, v245
v_lshlrev_b32 v53, 16, v245
v_and_b32 v54, 0xffff, v255
v_lshlrev_b32 v55, 16, v255
v_dot2c_f32_bf16 v20, v132, v52
v_dot2c_f32_bf16 v21, v132, v53
v_dot2c_f32_bf16 v28, v132, v54
v_dot2c_f32_bf16 v29, v132, v55
v_dot2c_f32_bf16 v22, v133, v52
v_dot2c_f32_bf16 v23, v133, v53
v_dot2c_f32_bf16 v30, v133, v54
v_dot2c_f32_bf16 v31, v133, v55
v_dot2c_f32_bf16 v24, v134, v52
v_dot2c_f32_bf16 v25, v134, v53
v_dot2c_f32_bf16 v32, v134, v54
v_dot2c_f32_bf16 v33, v134, v55
v_dot2c_f32_bf16 v26, v135, v52
v_dot2c_f32_bf16 v27, v135, v53
v_dot2c_f32_bf16 v34, v135, v54
v_dot2c_f32_bf16 v35, v135, v55
s_mov_b32 s63, 43008
buffer_load_dwordx4 v[196:199], v2, s[52:55], s63 offen nt
s_waitcnt vmcnt(15)
v_lshrrev_b32 v52, 16, v245
v_and_b32 v53, 0xffff0000, v245
v_lshrrev_b32 v54, 16, v255
v_and_b32 v55, 0xffff0000, v255
v_dot2c_f32_bf16 v20, v136, v52
v_dot2c_f32_bf16 v21, v136, v53
v_dot2c_f32_bf16 v28, v136, v54
v_dot2c_f32_bf16 v29, v136, v55
v_dot2c_f32_bf16 v22, v137, v52
v_dot2c_f32_bf16 v23, v137, v53
v_dot2c_f32_bf16 v30, v137, v54
v_dot2c_f32_bf16 v31, v137, v55
v_dot2c_f32_bf16 v24, v138, v52
v_dot2c_f32_bf16 v25, v138, v53
v_dot2c_f32_bf16 v32, v138, v54
v_dot2c_f32_bf16 v33, v138, v55
v_dot2c_f32_bf16 v26, v139, v52
v_dot2c_f32_bf16 v27, v139, v53
v_dot2c_f32_bf16 v34, v139, v54
v_dot2c_f32_bf16 v35, v139, v55
s_mov_b32 s63, 46080
buffer_load_dwordx4 v[200:203], v2, s[52:55], s63 offen nt
s_waitcnt vmcnt(15)
v_and_b32 v52, 0xffff, v236
v_lshlrev_b32 v53, 16, v236
v_and_b32 v54, 0xffff, v246
v_lshlrev_b32 v55, 16, v246
v_dot2c_f32_bf16 v36, v140, v52
v_dot2c_f32_bf16 v37, v140, v53
v_dot2c_f32_bf16 v44, v140, v54
v_dot2c_f32_bf16 v45, v140, v55
v_dot2c_f32_bf16 v38, v141, v52
v_dot2c_f32_bf16 v39, v141, v53
v_dot2c_f32_bf16 v46, v141, v54
v_dot2c_f32_bf16 v47, v141, v55
v_dot2c_f32_bf16 v40, v142, v52
v_dot2c_f32_bf16 v41, v142, v53
v_dot2c_f32_bf16 v48, v142, v54
v_dot2c_f32_bf16 v49, v142, v55
v_dot2c_f32_bf16 v42, v143, v52
v_dot2c_f32_bf16 v43, v143, v53
v_dot2c_f32_bf16 v50, v143, v54
v_dot2c_f32_bf16 v51, v143, v55
s_mov_b32 s63, 49152
buffer_load_dwordx4 v[204:207], v2, s[52:55], s63 offen nt
s_waitcnt vmcnt(15)
v_lshrrev_b32 v52, 16, v236
v_and_b32 v53, 0xffff0000, v236
v_lshrrev_b32 v54, 16, v246
v_and_b32 v55, 0xffff0000, v246
v_dot2c_f32_bf16 v36, v144, v52
v_dot2c_f32_bf16 v37, v144, v53
v_dot2c_f32_bf16 v44, v144, v54
v_dot2c_f32_bf16 v45, v144, v55
v_dot2c_f32_bf16 v38, v145, v52
v_dot2c_f32_bf16 v39, v145, v53
v_dot2c_f32_bf16 v46, v145, v54
v_dot2c_f32_bf16 v47, v145, v55
v_dot2c_f32_bf16 v40, v146, v52
v_dot2c_f32_bf16 v41, v146, v53
v_dot2c_f32_bf16 v48, v146, v54
v_dot2c_f32_bf16 v49, v146, v55
v_dot2c_f32_bf16 v42, v147, v52
v_dot2c_f32_bf16 v43, v147, v53
v_dot2c_f32_bf16 v50, v147, v54
v_dot2c_f32_bf16 v51, v147, v55
s_mov_b32 s63, 52224
buffer_load_dwordx4 v[208:211], v2, s[52:55], s63 offen nt
s_waitcnt vmcnt(15)
v_and_b32 v52, 0xffff, v237
v_lshlrev_b32 v53, 16, v237
v_and_b32 v54, 0xffff, v247
v_lshlrev_b32 v55, 16, v247
v_dot2c_f32_bf16 v36, v148, v52
v_dot2c_f32_bf16 v37, v148, v53
v_dot2c_f32_bf16 v44, v148, v54
v_dot2c_f32_bf16 v45, v148, v55
v_dot2c_f32_bf16 v38, v149, v52
v_dot2c_f32_bf16 v39, v149, v53
v_dot2c_f32_bf16 v46, v149, v54
v_dot2c_f32_bf16 v47, v149, v55
v_dot2c_f32_bf16 v40, v150, v52
v_dot2c_f32_bf16 v41, v150, v53
v_dot2c_f32_bf16 v48, v150, v54
v_dot2c_f32_bf16 v49, v150, v55
v_dot2c_f32_bf16 v42, v151, v52
v_dot2c_f32_bf16 v43, v151, v53
v_dot2c_f32_bf16 v50, v151, v54
v_dot2c_f32_bf16 v51, v151, v55
s_mov_b32 s63, 55296
buffer_load_dwordx4 v[212:215], v2, s[52:55], s63 offen nt
s_waitcnt vmcnt(15)
v_lshrrev_b32 v52, 16, v237
v_and_b32 v53, 0xffff0000, v237
v_lshrrev_b32 v54, 16, v247
v_and_b32 v55, 0xffff0000, v247
v_dot2c_f32_bf16 v36, v152, v52
v_dot2c_f32_bf16 v37, v152, v53
v_dot2c_f32_bf16 v44, v152, v54
v_dot2c_f32_bf16 v45, v152, v55
v_dot2c_f32_bf16 v38, v153, v52
v_dot2c_f32_bf16 v39, v153, v53
v_dot2c_f32_bf16 v46, v153, v54
v_dot2c_f32_bf16 v47, v153, v55
v_dot2c_f32_bf16 v40, v154, v52
v_dot2c_f32_bf16 v41, v154, v53
v_dot2c_f32_bf16 v48, v154, v54
v_dot2c_f32_bf16 v49, v154, v55
v_dot2c_f32_bf16 v42, v155, v52
v_dot2c_f32_bf16 v43, v155, v53
v_dot2c_f32_bf16 v50, v155, v54
v_dot2c_f32_bf16 v51, v155, v55
s_mov_b32 s63, 58368
buffer_load_dwordx4 v[216:219], v2, s[52:55], s63 offen nt
s_waitcnt vmcnt(15)
v_and_b32 v52, 0xffff, v238
v_lshlrev_b32 v53, 16, v238
v_and_b32 v54, 0xffff, v248
v_lshlrev_b32 v55, 16, v248
v_dot2c_f32_bf16 v36, v156, v52
v_dot2c_f32_bf16 v37, v156, v53
v_dot2c_f32_bf16 v44, v156, v54
v_dot2c_f32_bf16 v45, v156, v55
v_dot2c_f32_bf16 v38, v157, v52
v_dot2c_f32_bf16 v39, v157, v53
v_dot2c_f32_bf16 v46, v157, v54
v_dot2c_f32_bf16 v47, v157, v55
v_dot2c_f32_bf16 v40, v158, v52
v_dot2c_f32_bf16 v41, v158, v53
v_dot2c_f32_bf16 v48, v158, v54
v_dot2c_f32_bf16 v49, v158, v55
v_dot2c_f32_bf16 v42, v159, v52
v_dot2c_f32_bf16 v43, v159, v53
v_dot2c_f32_bf16 v50, v159, v54
v_dot2c_f32_bf16 v51, v159, v55
s_mov_b32 s63, 0
buffer_load_dwordx4 v[60:63], v3, s[28:31], s63 offen offset:0 nt
s_waitcnt vmcnt(15)
v_lshrrev_b32 v52, 16, v238
v_and_b32 v53, 0xffff0000, v238
v_lshrrev_b32 v54, 16, v248
v_and_b32 v55, 0xffff0000, v248
v_dot2c_f32_bf16 v36, v160, v52
v_dot2c_f32_bf16 v37, v160, v53
v_dot2c_f32_bf16 v44, v160, v54
v_dot2c_f32_bf16 v45, v160, v55
v_dot2c_f32_bf16 v38, v161, v52
v_dot2c_f32_bf16 v39, v161, v53
v_dot2c_f32_bf16 v46, v161, v54
v_dot2c_f32_bf16 v47, v161, v55
v_dot2c_f32_bf16 v40, v162, v52
v_dot2c_f32_bf16 v41, v162, v53
v_dot2c_f32_bf16 v48, v162, v54
v_dot2c_f32_bf16 v49, v162, v55
v_dot2c_f32_bf16 v42, v163, v52
v_dot2c_f32_bf16 v43, v163, v53
v_dot2c_f32_bf16 v50, v163, v54
v_dot2c_f32_bf16 v51, v163, v55
s_mov_b32 s63, 0
buffer_load_dwordx4 v[64:67], v3, s[28:31], s63 offen offset:256 nt
s_waitcnt vmcnt(15)
v_and_b32 v52, 0xffff, v239
v_lshlrev_b32 v53, 16, v239
v_and_b32 v54, 0xffff, v249
v_lshlrev_b32 v55, 16, v249
v_dot2c_f32_bf16 v36, v164, v52
v_dot2c_f32_bf16 v37, v164, v53
v_dot2c_f32_bf16 v44, v164, v54
v_dot2c_f32_bf16 v45, v164, v55
v_dot2c_f32_bf16 v38, v165, v52
v_dot2c_f32_bf16 v39, v165, v53
v_dot2c_f32_bf16 v46, v165, v54
v_dot2c_f32_bf16 v47, v165, v55
v_dot2c_f32_bf16 v40, v166, v52
v_dot2c_f32_bf16 v41, v166, v53
v_dot2c_f32_bf16 v48, v166, v54
v_dot2c_f32_bf16 v49, v166, v55
v_dot2c_f32_bf16 v42, v167, v52
v_dot2c_f32_bf16 v43, v167, v53
v_dot2c_f32_bf16 v50, v167, v54
v_dot2c_f32_bf16 v51, v167, v55
s_mov_b32 s63, 0
buffer_load_dwordx4 v[68:71], v3, s[28:31], s63 offen offset:512 nt
s_waitcnt vmcnt(15)
v_lshrrev_b32 v52, 16, v239
v_and_b32 v53, 0xffff0000, v239
v_lshrrev_b32 v54, 16, v249
v_and_b32 v55, 0xffff0000, v249
v_dot2c_f32_bf16 v36, v168, v52
v_dot2c_f32_bf16 v37, v168, v53
v_dot2c_f32_bf16 v44, v168, v54
v_dot2c_f32_bf16 v45, v168, v55
v_dot2c_f32_bf16 v38, v169, v52
v_dot2c_f32_bf16 v39, v169, v53
v_dot2c_f32_bf16 v46, v169, v54
v_dot2c_f32_bf16 v47, v169, v55
v_dot2c_f32_bf16 v40, v170, v52
v_dot2c_f32_bf16 v41, v170, v53
v_dot2c_f32_bf16 v48, v170, v54
v_dot2c_f32_bf16 v49, v170, v55
v_dot2c_f32_bf16 v42, v171, v52
v_dot2c_f32_bf16 v43, v171, v53
v_dot2c_f32_bf16 v50, v171, v54
v_dot2c_f32_bf16 v51, v171, v55
s_mov_b32 s63, 0
buffer_load_dwordx4 v[72:75], v3, s[28:31], s63 offen offset:768 nt
s_waitcnt vmcnt(15)
v_and_b32 v52, 0xffff, v240
v_lshlrev_b32 v53, 16, v240
v_and_b32 v54, 0xffff, v250
v_lshlrev_b32 v55, 16, v250
v_dot2c_f32_bf16 v36, v172, v52
v_dot2c_f32_bf16 v37, v172, v53
v_dot2c_f32_bf16 v44, v172, v54
v_dot2c_f32_bf16 v45, v172, v55
v_dot2c_f32_bf16 v38, v173, v52
v_dot2c_f32_bf16 v39, v173, v53
v_dot2c_f32_bf16 v46, v173, v54
v_dot2c_f32_bf16 v47, v173, v55
v_dot2c_f32_bf16 v40, v174, v52
v_dot2c_f32_bf16 v41, v174, v53
v_dot2c_f32_bf16 v48, v174, v54
v_dot2c_f32_bf16 v49, v174, v55
v_dot2c_f32_bf16 v42, v175, v52
v_dot2c_f32_bf16 v43, v175, v53
v_dot2c_f32_bf16 v50, v175, v54
v_dot2c_f32_bf16 v51, v175, v55
s_mov_b32 s63, 0
buffer_load_dwordx4 v[76:79], v3, s[28:31], s63 offen offset:1024 nt
s_waitcnt vmcnt(15)
v_lshrrev_b32 v52, 16, v240
v_and_b32 v53, 0xffff0000, v240
v_lshrrev_b32 v54, 16, v250
v_and_b32 v55, 0xffff0000, v250
v_dot2c_f32_bf16 v36, v176, v52
v_dot2c_f32_bf16 v37, v176, v53
v_dot2c_f32_bf16 v44, v176, v54
v_dot2c_f32_bf16 v45, v176, v55
v_dot2c_f32_bf16 v38, v177, v52
v_dot2c_f32_bf16 v39, v177, v53
v_dot2c_f32_bf16 v46, v177, v54
v_dot2c_f32_bf16 v47, v177, v55
v_dot2c_f32_bf16 v40, v178, v52
v_dot2c_f32_bf16 v41, v178, v53
v_dot2c_f32_bf16 v48, v178, v54
v_dot2c_f32_bf16 v49, v178, v55
v_dot2c_f32_bf16 v42, v179, v52
v_dot2c_f32_bf16 v43, v179, v53
v_dot2c_f32_bf16 v50, v179, v54
v_dot2c_f32_bf16 v51, v179, v55
s_mov_b32 s63, 1280
buffer_load_dwordx4 v[80:83], v3, s[28:31], s63 offen offset:0 nt
s_waitcnt vmcnt(15)
v_and_b32 v52, 0xffff, v241
v_lshlrev_b32 v53, 16, v241
v_and_b32 v54, 0xffff, v251
v_lshlrev_b32 v55, 16, v251
v_dot2c_f32_bf16 v36, v180, v52
v_dot2c_f32_bf16 v37, v180, v53
v_dot2c_f32_bf16 v44, v180, v54
v_dot2c_f32_bf16 v45, v180, v55
v_dot2c_f32_bf16 v38, v181, v52
v_dot2c_f32_bf16 v39, v181, v53
v_dot2c_f32_bf16 v46, v181, v54
v_dot2c_f32_bf16 v47, v181, v55
v_dot2c_f32_bf16 v40, v182, v52
v_dot2c_f32_bf16 v41, v182, v53
v_dot2c_f32_bf16 v48, v182, v54
v_dot2c_f32_bf16 v49, v182, v55
v_dot2c_f32_bf16 v42, v183, v52
v_dot2c_f32_bf16 v43, v183, v53
v_dot2c_f32_bf16 v50, v183, v54
v_dot2c_f32_bf16 v51, v183, v55
s_mov_b32 s63, 1280
buffer_load_dwordx4 v[84:87], v3, s[28:31], s63 offen offset:256 nt
s_waitcnt vmcnt(15)
v_lshrrev_b32 v52, 16, v241
v_and_b32 v53, 0xffff0000, v241
v_lshrrev_b32 v54, 16, v251
v_and_b32 v55, 0xffff0000, v251
v_dot2c_f32_bf16 v36, v184, v52
v_dot2c_f32_bf16 v37, v184, v53
v_dot2c_f32_bf16 v44, v184, v54
v_dot2c_f32_bf16 v45, v184, v55
v_dot2c_f32_bf16 v38, v185, v52
v_dot2c_f32_bf16 v39, v185, v53
v_dot2c_f32_bf16 v46, v185, v54
v_dot2c_f32_bf16 v47, v185, v55
v_dot2c_f32_bf16 v40, v186, v52
v_dot2c_f32_bf16 v41, v186, v53
v_dot2c_f32_bf16 v48, v186, v54
v_dot2c_f32_bf16 v49, v186, v55
v_dot2c_f32_bf16 v42, v187, v52
v_dot2c_f32_bf16 v43, v187, v53
v_dot2c_f32_bf16 v50, v187, v54
v_dot2c_f32_bf16 v51, v187, v55
s_mov_b32 s63, 1280
buffer_load_dwordx4 v[88:91], v3, s[28:31], s63 offen offset:512 nt
s_waitcnt vmcnt(15)
v_and_b32 v52, 0xffff, v242
v_lshlrev_b32 v53, 16, v242
v_and_b32 v54, 0xffff, v252
v_lshlrev_b32 v55, 16, v252
v_dot2c_f32_bf16 v36, v188, v52
v_dot2c_f32_bf16 v37, v188, v53
v_dot2c_f32_bf16 v44, v188, v54
v_dot2c_f32_bf16 v45, v188, v55
v_dot2c_f32_bf16 v38, v189, v52
v_dot2c_f32_bf16 v39, v189, v53
v_dot2c_f32_bf16 v46, v189, v54
v_dot2c_f32_bf16 v47, v189, v55
v_dot2c_f32_bf16 v40, v190, v52
v_dot2c_f32_bf16 v41, v190, v53
v_dot2c_f32_bf16 v48, v190, v54
v_dot2c_f32_bf16 v49, v190, v55
v_dot2c_f32_bf16 v42, v191, v52
v_dot2c_f32_bf16 v43, v191, v53
v_dot2c_f32_bf16 v50, v191, v54
v_dot2c_f32_bf16 v51, v191, v55
s_mov_b32 s63, 1280
buffer_load_dwordx4 v[92:95], v3, s[28:31], s63 offen offset:768 nt
s_waitcnt vmcnt(15)
v_lshrrev_b32 v52, 16, v242
v_and_b32 v53, 0xffff0000, v242
v_lshrrev_b32 v54, 16, v252
v_and_b32 v55, 0xffff0000, v252
v_dot2c_f32_bf16 v36, v192, v52
v_dot2c_f32_bf16 v37, v192, v53
v_dot2c_f32_bf16 v44, v192, v54
v_dot2c_f32_bf16 v45, v192, v55
v_dot2c_f32_bf16 v38, v193, v52
v_dot2c_f32_bf16 v39, v193, v53
v_dot2c_f32_bf16 v46, v193, v54
v_dot2c_f32_bf16 v47, v193, v55
v_dot2c_f32_bf16 v40, v194, v52
v_dot2c_f32_bf16 v41, v194, v53
v_dot2c_f32_bf16 v48, v194, v54
v_dot2c_f32_bf16 v49, v194, v55
v_dot2c_f32_bf16 v42, v195, v52
v_dot2c_f32_bf16 v43, v195, v53
v_dot2c_f32_bf16 v50, v195, v54
v_dot2c_f32_bf16 v51, v195, v55
s_mov_b32 s63, 1280
buffer_load_dwordx4 v[96:99], v3, s[28:31], s63 offen offset:1024 nt
s_waitcnt vmcnt(15)
v_and_b32 v52, 0xffff, v243
v_lshlrev_b32 v53, 16, v243
v_and_b32 v54, 0xffff, v253
v_lshlrev_b32 v55, 16, v253
v_dot2c_f32_bf16 v36, v196, v52
v_dot2c_f32_bf16 v37, v196, v53
v_dot2c_f32_bf16 v44, v196, v54
v_dot2c_f32_bf16 v45, v196, v55
v_dot2c_f32_bf16 v38, v197, v52
v_dot2c_f32_bf16 v39, v197, v53
v_dot2c_f32_bf16 v46, v197, v54
v_dot2c_f32_bf16 v47, v197, v55
v_dot2c_f32_bf16 v40, v198, v52
v_dot2c_f32_bf16 v41, v198, v53
v_dot2c_f32_bf16 v48, v198, v54
v_dot2c_f32_bf16 v49, v198, v55
v_dot2c_f32_bf16 v42, v199, v52
v_dot2c_f32_bf16 v43, v199, v53
v_dot2c_f32_bf16 v50, v199, v54
v_dot2c_f32_bf16 v51, v199, v55
s_mov_b32 s63, 2560
buffer_load_dwordx4 v[100:103], v3, s[28:31], s63 offen offset:0 nt
s_waitcnt vmcnt(15)
v_lshrrev_b32 v52, 16, v243
v_and_b32 v53, 0xffff0000, v243
v_lshrrev_b32 v54, 16, v253
v_and_b32 v55, 0xffff0000, v253
v_dot2c_f32_bf16 v36, v200, v52
v_dot2c_f32_bf16 v37, v200, v53
v_dot2c_f32_bf16 v44, v200, v54
v_dot2c_f32_bf16 v45, v200, v55
v_dot2c_f32_bf16 v38, v201, v52
v_dot2c_f32_bf16 v39, v201, v53
v_dot2c_f32_bf16 v46, v201, v54
v_dot2c_f32_bf16 v47, v201, v55
v_dot2c_f32_bf16 v40, v202, v52
v_dot2c_f32_bf16 v41, v202, v53
v_dot2c_f32_bf16 v48, v202, v54
v_dot2c_f32_bf16 v49, v202, v55
v_dot2c_f32_bf16 v42, v203, v52
v_dot2c_f32_bf16 v43, v203, v53
v_dot2c_f32_bf16 v50, v203, v54
v_dot2c_f32_bf16 v51, v203, v55
s_mov_b32 s63, 2560
buffer_load_dwordx4 v[104:107], v3, s[28:31], s63 offen offset:256 nt
s_waitcnt vmcnt(15)
v_and_b32 v52, 0xffff, v244
v_lshlrev_b32 v53, 16, v244
v_and_b32 v54, 0xffff, v254
v_lshlrev_b32 v55, 16, v254
v_dot2c_f32_bf16 v36, v204, v52
v_dot2c_f32_bf16 v37, v204, v53
v_dot2c_f32_bf16 v44, v204, v54
v_dot2c_f32_bf16 v45, v204, v55
v_dot2c_f32_bf16 v38, v205, v52
v_dot2c_f32_bf16 v39, v205, v53
v_dot2c_f32_bf16 v46, v205, v54
v_dot2c_f32_bf16 v47, v205, v55
v_dot2c_f32_bf16 v40, v206, v52
v_dot2c_f32_bf16 v41, v206, v53
v_dot2c_f32_bf16 v48, v206, v54
v_dot2c_f32_bf16 v49, v206, v55
v_dot2c_f32_bf16 v42, v207, v52
v_dot2c_f32_bf16 v43, v207, v53
v_dot2c_f32_bf16 v50, v207, v54
v_dot2c_f32_bf16 v51, v207, v55
s_mov_b32 s63, 2560
buffer_load_dwordx4 v[108:111], v3, s[28:31], s63 offen offset:512 nt
s_waitcnt vmcnt(15)
v_lshrrev_b32 v52, 16, v244
v_and_b32 v53, 0xffff0000, v244
v_lshrrev_b32 v54, 16, v254
v_and_b32 v55, 0xffff0000, v254
v_dot2c_f32_bf16 v36, v208, v52
v_dot2c_f32_bf16 v37, v208, v53
v_dot2c_f32_bf16 v44, v208, v54
v_dot2c_f32_bf16 v45, v208, v55
v_dot2c_f32_bf16 v38, v209, v52
v_dot2c_f32_bf16 v39, v209, v53
v_dot2c_f32_bf16 v46, v209, v54
v_dot2c_f32_bf16 v47, v209, v55
v_dot2c_f32_bf16 v40, v210, v52
v_dot2c_f32_bf16 v41, v210, v53
v_dot2c_f32_bf16 v48, v210, v54
v_dot2c_f32_bf16 v49, v210, v55
v_dot2c_f32_bf16 v42, v211, v52
v_dot2c_f32_bf16 v43, v211, v53
v_dot2c_f32_bf16 v50, v211, v54
v_dot2c_f32_bf16 v51, v211, v55
s_mov_b32 s63, 2560
buffer_load_dwordx4 v[112:115], v3, s[28:31], s63 offen offset:768 nt
s_waitcnt vmcnt(15)
v_and_b32 v52, 0xffff, v245
v_lshlrev_b32 v53, 16, v245
v_and_b32 v54, 0xffff, v255
v_lshlrev_b32 v55, 16, v255
v_dot2c_f32_bf16 v36, v212, v52
v_dot2c_f32_bf16 v37, v212, v53
v_dot2c_f32_bf16 v44, v212, v54
v_dot2c_f32_bf16 v45, v212, v55
v_dot2c_f32_bf16 v38, v213, v52
v_dot2c_f32_bf16 v39, v213, v53
v_dot2c_f32_bf16 v46, v213, v54
v_dot2c_f32_bf16 v47, v213, v55
v_dot2c_f32_bf16 v40, v214, v52
v_dot2c_f32_bf16 v41, v214, v53
v_dot2c_f32_bf16 v48, v214, v54
v_dot2c_f32_bf16 v49, v214, v55
v_dot2c_f32_bf16 v42, v215, v52
v_dot2c_f32_bf16 v43, v215, v53
v_dot2c_f32_bf16 v50, v215, v54
v_dot2c_f32_bf16 v51, v215, v55
s_mov_b32 s63, 2560
buffer_load_dwordx4 v[116:119], v3, s[28:31], s63 offen offset:1024 nt
s_waitcnt vmcnt(15)
v_lshrrev_b32 v52, 16, v245
v_and_b32 v53, 0xffff0000, v245
v_lshrrev_b32 v54, 16, v255
v_and_b32 v55, 0xffff0000, v255
v_dot2c_f32_bf16 v36, v216, v52
v_dot2c_f32_bf16 v37, v216, v53
v_dot2c_f32_bf16 v44, v216, v54
v_dot2c_f32_bf16 v45, v216, v55
v_dot2c_f32_bf16 v38, v217, v52
v_dot2c_f32_bf16 v39, v217, v53
v_dot2c_f32_bf16 v46, v217, v54
v_dot2c_f32_bf16 v47, v217, v55
v_dot2c_f32_bf16 v40, v218, v52
v_dot2c_f32_bf16 v41, v218, v53
v_dot2c_f32_bf16 v48, v218, v54
v_dot2c_f32_bf16 v49, v218, v55
v_dot2c_f32_bf16 v42, v219, v52
v_dot2c_f32_bf16 v43, v219, v53
v_dot2c_f32_bf16 v50, v219, v54
v_dot2c_f32_bf16 v51, v219, v55
s_mov_b32 s63, 3840
buffer_load_dwordx4 v[120:123], v3, s[28:31], s63 offen offset:0 nt
v_permlane32_swap_b32 v20, v28
v_permlane32_swap_b32 v21, v29
v_permlane32_swap_b32 v22, v30
v_permlane32_swap_b32 v23, v31
v_permlane32_swap_b32 v24, v32
v_permlane32_swap_b32 v25, v33
v_permlane32_swap_b32 v26, v34
v_permlane32_swap_b32 v27, v35
v_add_f32 v20, v20, v28
v_add_f32 v21, v21, v29
v_add_f32 v22, v22, v30
v_add_f32 v23, v23, v31
v_add_f32 v24, v24, v32
v_add_f32 v25, v25, v33
v_add_f32 v26, v26, v34
v_add_f32 v27, v27, v35
v_permlane16_swap_b32 v20, v24
v_permlane16_swap_b32 v21, v25
v_permlane16_swap_b32 v22, v26
v_permlane16_swap_b32 v23, v27
v_add_f32 v20, v20, v24
v_add_f32 v21, v21, v25
v_add_f32 v22, v22, v26
v_add_f32 v23, v23, v27
v_add_f32_dpp v20, v20, v20 row_ror:8 row_mask:0xf bank_mask:0xf
v_add_f32_dpp v21, v21, v21 row_ror:8 row_mask:0xf bank_mask:0xf
v_add_f32_dpp v22, v22, v22 row_ror:8 row_mask:0xf bank_mask:0xf
v_add_f32_dpp v23, v23, v23 row_ror:8 row_mask:0xf bank_mask:0xf
v_lshrrev_b32 v6, 5, v1
v_lshlrev_b32 v6, 8, v6
v_and_b32 v7, 7, v1
v_lshl_add_u32 v6, v7, 5, v6
v_bfe_u32 v7, v1, 4, 1
v_lshl_add_u32 v6, v7, 4, v6
s_lshl_b32 s62, s56, 9
v_add_u32 v6, s62, v6
ds_write_b128 v6, v[20:23] offset:2560
v_permlane32_swap_b32 v36, v44
v_permlane32_swap_b32 v37, v45
v_permlane32_swap_b32 v38, v46
v_permlane32_swap_b32 v39, v47
v_permlane32_swap_b32 v40, v48
v_permlane32_swap_b32 v41, v49
v_permlane32_swap_b32 v42, v50
v_permlane32_swap_b32 v43, v51
v_add_f32 v36, v36, v44
v_add_f32 v37, v37, v45
v_add_f32 v38, v38, v46
v_add_f32 v39, v39, v47
v_add_f32 v40, v40, v48
v_add_f32 v41, v41, v49
v_add_f32 v42, v42, v50
v_add_f32 v43, v43, v51
v_permlane16_swap_b32 v36, v40
v_permlane16_swap_b32 v37, v41
v_permlane16_swap_b32 v38, v42
v_permlane16_swap_b32 v39, v43
v_add_f32 v36, v36, v40
v_add_f32 v37, v37, v41
v_add_f32 v38, v38, v42
v_add_f32 v39, v39, v43
v_add_f32_dpp v36, v36, v36 row_ror:8 row_mask:0xf bank_mask:0xf
v_add_f32_dpp v37, v37, v37 row_ror:8 row_mask:0xf bank_mask:0xf
v_add_f32_dpp v38, v38, v38 row_ror:8 row_mask:0xf bank_mask:0xf
v_add_f32_dpp v39, v39, v39 row_ror:8 row_mask:0xf bank_mask:0xf
v_lshrrev_b32 v6, 5, v1
v_lshlrev_b32 v6, 8, v6
v_and_b32 v7, 7, v1
v_lshl_add_u32 v6, v7, 5, v6
v_bfe_u32 v7, v1, 4, 1
v_lshl_add_u32 v6, v7, 4, v6
s_lshl_b32 s62, s56, 9
v_add_u32 v6, s62, v6
ds_write_b128 v6, v[36:39] offset:4608
s_mov_b32 s63, 3840
buffer_load_dwordx4 v[124:127], v3, s[28:31], s63 offen offset:256 nt
s_mov_b32 s63, 3840
buffer_load_dwordx4 v[128:131], v3, s[28:31], s63 offen offset:512 nt
s_mov_b32 s63, 3840
buffer_load_dwordx4 v[132:135], v3, s[28:31], s63 offen offset:768 nt
s_mov_b32 s63, 3840
buffer_load_dwordx4 v[136:139], v3, s[28:31], s63 offen offset:1024 nt
s_waitcnt lgkmcnt(0)
s_barrier
s_cmp_ge_u32 s56, 2
s_cbranch_scc1 L_ffn_h
v_lshlrev_b32 v6, 2, v0
ds_read_b32 v20, v6 offset:2560
ds_read_b32 v24, v6 offset:4608
ds_read_b32 v21, v6 offset:3072
ds_read_b32 v25, v6 offset:5120
ds_read_b32 v22, v6 offset:3584
ds_read_b32 v26, v6 offset:5632
ds_read_b32 v23, v6 offset:4096
ds_read_b32 v27, v6 offset:6144
s_waitcnt lgkmcnt(0)
v_add_f32 v20, v20, v21
v_add_f32 v22, v22, v23
v_add_f32 v24, v24, v25
v_add_f32 v26, v26, v27
v_add_f32 v20, v20, v22
v_add_f32 v24, v24, v26
v_cvt_pk_bf16_f32 v28, v20, v24
v_lshlrev_b32 v20, 16, v28
v_and_b32 v24, 0xffff0000, v28
v_mul_f32 v25, v20, v20
v_mul_f32 v25, v25, v20
s_mov_b32 s22, 0x3d372713
v_fma_f32 v25, v25, s22, v20
s_mov_b32 s22, 0xc0135761
v_mul_f32 v25, s22, v25
v_exp_f32 v25, v25
s_nop 0
v_add_f32 v25, 1.0, v25
v_rcp_f32 v25, v25
s_nop 0
v_mul_f32 v20, v20, v25
v_cvt_pk_bf16_f32 v20, v20, v20
v_and_b32 v20, 0xffff0000, v20
v_mul_f32 v20, v20, v24
v_cvt_pk_bf16_f32 v20, v20, v20
v_lshlrev_b32 v6, 1, v0
ds_write_b16 v6, v20 offset:19584
s_waitcnt lgkmcnt(0)
L_ffn_h:
s_barrier
v_lshrrev_b32 v6, 4, v1
v_lshlrev_b32 v6, 3, v6
s_lshl_b32 s62, s56, 5
v_add_u32 v6, s62, v6
ds_read_b64 v[56:57], v6 offset:19584
ds_read_b64 v[58:59], v6 offset:19712
v_mov_b32 v140, 0
v_mov_b32 v141, 0
v_mov_b32 v142, 0
v_mov_b32 v143, 0
v_mov_b32 v144, 0
v_mov_b32 v145, 0
v_mov_b32 v146, 0
v_mov_b32 v147, 0
v_mov_b32 v148, 0
v_mov_b32 v149, 0
v_mov_b32 v150, 0
v_mov_b32 v151, 0
v_mov_b32 v152, 0
v_mov_b32 v153, 0
v_mov_b32 v154, 0
v_mov_b32 v155, 0
v_mov_b32 v156, 0
v_mov_b32 v157, 0
v_mov_b32 v158, 0
v_mov_b32 v159, 0
v_mov_b32 v160, 0
v_mov_b32 v161, 0
v_mov_b32 v162, 0
v_mov_b32 v163, 0
v_mov_b32 v164, 0
v_mov_b32 v165, 0
v_mov_b32 v166, 0
v_mov_b32 v167, 0
v_mov_b32 v168, 0
v_mov_b32 v169, 0
v_mov_b32 v170, 0
v_mov_b32 v171, 0
v_mov_b32 v172, 0
v_mov_b32 v173, 0
v_mov_b32 v174, 0
v_mov_b32 v175, 0
v_mov_b32 v176, 0
v_mov_b32 v177, 0
v_mov_b32 v178, 0
v_mov_b32 v179, 0
v_mov_b32 v180, 0
v_mov_b32 v181, 0
v_mov_b32 v182, 0
v_mov_b32 v183, 0
v_mov_b32 v184, 0
v_mov_b32 v185, 0
v_mov_b32 v186, 0
v_mov_b32 v187, 0
v_mov_b32 v188, 0
v_mov_b32 v189, 0
v_mov_b32 v190, 0
v_mov_b32 v191, 0
v_mov_b32 v192, 0
v_mov_b32 v193, 0
v_mov_b32 v194, 0
v_mov_b32 v195, 0
v_mov_b32 v196, 0
v_mov_b32 v197, 0
v_mov_b32 v198, 0
v_mov_b32 v199, 0
v_mov_b32 v200, 0
v_mov_b32 v201, 0
v_mov_b32 v202, 0
v_mov_b32 v203, 0
v_mov_b32 v204, 0
v_mov_b32 v205, 0
v_mov_b32 v206, 0
v_mov_b32 v207, 0
v_mov_b32 v208, 0
v_mov_b32 v209, 0
v_mov_b32 v210, 0
v_mov_b32 v211, 0
v_mov_b32 v212, 0
v_mov_b32 v213, 0
v_mov_b32 v214, 0
v_mov_b32 v215, 0
v_mov_b32 v216, 0
v_mov_b32 v217, 0
v_mov_b32 v218, 0
v_mov_b32 v219, 0
s_waitcnt vmcnt(0) lgkmcnt(0)
v_and_b32 v52, 0xffff, v56
v_lshlrev_b32 v53, 16, v56
v_and_b32 v54, 0xffff, v58
v_lshlrev_b32 v55, 16, v58
v_dot2c_f32_bf16 v140, v60, v52
v_dot2c_f32_bf16 v141, v60, v53
v_dot2c_f32_bf16 v148, v60, v54
v_dot2c_f32_bf16 v149, v60, v55
v_dot2c_f32_bf16 v142, v61, v52
v_dot2c_f32_bf16 v143, v61, v53
v_dot2c_f32_bf16 v150, v61, v54
v_dot2c_f32_bf16 v151, v61, v55
v_dot2c_f32_bf16 v144, v62, v52
v_dot2c_f32_bf16 v145, v62, v53
v_dot2c_f32_bf16 v152, v62, v54
v_dot2c_f32_bf16 v153, v62, v55
v_dot2c_f32_bf16 v146, v63, v52
v_dot2c_f32_bf16 v147, v63, v53
v_dot2c_f32_bf16 v154, v63, v54
v_dot2c_f32_bf16 v155, v63, v55
v_dot2c_f32_bf16 v156, v64, v52
v_dot2c_f32_bf16 v157, v64, v53
v_dot2c_f32_bf16 v164, v64, v54
v_dot2c_f32_bf16 v165, v64, v55
v_dot2c_f32_bf16 v158, v65, v52
v_dot2c_f32_bf16 v159, v65, v53
v_dot2c_f32_bf16 v166, v65, v54
v_dot2c_f32_bf16 v167, v65, v55
v_dot2c_f32_bf16 v160, v66, v52
v_dot2c_f32_bf16 v161, v66, v53
v_dot2c_f32_bf16 v168, v66, v54
v_dot2c_f32_bf16 v169, v66, v55
v_dot2c_f32_bf16 v162, v67, v52
v_dot2c_f32_bf16 v163, v67, v53
v_dot2c_f32_bf16 v170, v67, v54
v_dot2c_f32_bf16 v171, v67, v55
v_dot2c_f32_bf16 v172, v68, v52
v_dot2c_f32_bf16 v173, v68, v53
v_dot2c_f32_bf16 v180, v68, v54
v_dot2c_f32_bf16 v181, v68, v55
v_dot2c_f32_bf16 v174, v69, v52
v_dot2c_f32_bf16 v175, v69, v53
v_dot2c_f32_bf16 v182, v69, v54
v_dot2c_f32_bf16 v183, v69, v55
v_dot2c_f32_bf16 v176, v70, v52
v_dot2c_f32_bf16 v177, v70, v53
v_dot2c_f32_bf16 v184, v70, v54
v_dot2c_f32_bf16 v185, v70, v55
v_dot2c_f32_bf16 v178, v71, v52
v_dot2c_f32_bf16 v179, v71, v53
v_dot2c_f32_bf16 v186, v71, v54
v_dot2c_f32_bf16 v187, v71, v55
v_dot2c_f32_bf16 v188, v72, v52
v_dot2c_f32_bf16 v189, v72, v53
v_dot2c_f32_bf16 v196, v72, v54
v_dot2c_f32_bf16 v197, v72, v55
v_dot2c_f32_bf16 v190, v73, v52
v_dot2c_f32_bf16 v191, v73, v53
v_dot2c_f32_bf16 v198, v73, v54
v_dot2c_f32_bf16 v199, v73, v55
v_dot2c_f32_bf16 v192, v74, v52
v_dot2c_f32_bf16 v193, v74, v53
v_dot2c_f32_bf16 v200, v74, v54
v_dot2c_f32_bf16 v201, v74, v55
v_dot2c_f32_bf16 v194, v75, v52
v_dot2c_f32_bf16 v195, v75, v53
v_dot2c_f32_bf16 v202, v75, v54
v_dot2c_f32_bf16 v203, v75, v55
v_dot2c_f32_bf16 v204, v76, v52
v_dot2c_f32_bf16 v205, v76, v53
v_dot2c_f32_bf16 v212, v76, v54
v_dot2c_f32_bf16 v213, v76, v55
v_dot2c_f32_bf16 v206, v77, v52
v_dot2c_f32_bf16 v207, v77, v53
v_dot2c_f32_bf16 v214, v77, v54
v_dot2c_f32_bf16 v215, v77, v55
v_dot2c_f32_bf16 v208, v78, v52
v_dot2c_f32_bf16 v209, v78, v53
v_dot2c_f32_bf16 v216, v78, v54
v_dot2c_f32_bf16 v217, v78, v55
v_dot2c_f32_bf16 v210, v79, v52
v_dot2c_f32_bf16 v211, v79, v53
v_dot2c_f32_bf16 v218, v79, v54
v_dot2c_f32_bf16 v219, v79, v55
v_lshrrev_b32 v52, 16, v56
v_and_b32 v53, 0xffff0000, v56
v_lshrrev_b32 v54, 16, v58
v_and_b32 v55, 0xffff0000, v58
v_dot2c_f32_bf16 v140, v80, v52
v_dot2c_f32_bf16 v141, v80, v53
v_dot2c_f32_bf16 v148, v80, v54
v_dot2c_f32_bf16 v149, v80, v55
v_dot2c_f32_bf16 v142, v81, v52
v_dot2c_f32_bf16 v143, v81, v53
v_dot2c_f32_bf16 v150, v81, v54
v_dot2c_f32_bf16 v151, v81, v55
v_dot2c_f32_bf16 v144, v82, v52
v_dot2c_f32_bf16 v145, v82, v53
v_dot2c_f32_bf16 v152, v82, v54
v_dot2c_f32_bf16 v153, v82, v55
v_dot2c_f32_bf16 v146, v83, v52
v_dot2c_f32_bf16 v147, v83, v53
v_dot2c_f32_bf16 v154, v83, v54
v_dot2c_f32_bf16 v155, v83, v55
v_dot2c_f32_bf16 v156, v84, v52
v_dot2c_f32_bf16 v157, v84, v53
v_dot2c_f32_bf16 v164, v84, v54
v_dot2c_f32_bf16 v165, v84, v55
v_dot2c_f32_bf16 v158, v85, v52
v_dot2c_f32_bf16 v159, v85, v53
v_dot2c_f32_bf16 v166, v85, v54
v_dot2c_f32_bf16 v167, v85, v55
v_dot2c_f32_bf16 v160, v86, v52
v_dot2c_f32_bf16 v161, v86, v53
v_dot2c_f32_bf16 v168, v86, v54
v_dot2c_f32_bf16 v169, v86, v55
v_dot2c_f32_bf16 v162, v87, v52
v_dot2c_f32_bf16 v163, v87, v53
v_dot2c_f32_bf16 v170, v87, v54
v_dot2c_f32_bf16 v171, v87, v55
v_dot2c_f32_bf16 v172, v88, v52
v_dot2c_f32_bf16 v173, v88, v53
v_dot2c_f32_bf16 v180, v88, v54
v_dot2c_f32_bf16 v181, v88, v55
v_dot2c_f32_bf16 v174, v89, v52
v_dot2c_f32_bf16 v175, v89, v53
v_dot2c_f32_bf16 v182, v89, v54
v_dot2c_f32_bf16 v183, v89, v55
v_dot2c_f32_bf16 v176, v90, v52
v_dot2c_f32_bf16 v177, v90, v53
v_dot2c_f32_bf16 v184, v90, v54
v_dot2c_f32_bf16 v185, v90, v55
v_dot2c_f32_bf16 v178, v91, v52
v_dot2c_f32_bf16 v179, v91, v53
v_dot2c_f32_bf16 v186, v91, v54
v_dot2c_f32_bf16 v187, v91, v55
v_dot2c_f32_bf16 v188, v92, v52
v_dot2c_f32_bf16 v189, v92, v53
v_dot2c_f32_bf16 v196, v92, v54
v_dot2c_f32_bf16 v197, v92, v55
v_dot2c_f32_bf16 v190, v93, v52
v_dot2c_f32_bf16 v191, v93, v53
v_dot2c_f32_bf16 v198, v93, v54
v_dot2c_f32_bf16 v199, v93, v55
v_dot2c_f32_bf16 v192, v94, v52
v_dot2c_f32_bf16 v193, v94, v53
v_dot2c_f32_bf16 v200, v94, v54
v_dot2c_f32_bf16 v201, v94, v55
v_dot2c_f32_bf16 v194, v95, v52
v_dot2c_f32_bf16 v195, v95, v53
v_dot2c_f32_bf16 v202, v95, v54
v_dot2c_f32_bf16 v203, v95, v55
v_dot2c_f32_bf16 v204, v96, v52
v_dot2c_f32_bf16 v205, v96, v53
v_dot2c_f32_bf16 v212, v96, v54
v_dot2c_f32_bf16 v213, v96, v55
v_dot2c_f32_bf16 v206, v97, v52
v_dot2c_f32_bf16 v207, v97, v53
v_dot2c_f32_bf16 v214, v97, v54
v_dot2c_f32_bf16 v215, v97, v55
v_dot2c_f32_bf16 v208, v98, v52
v_dot2c_f32_bf16 v209, v98, v53
v_dot2c_f32_bf16 v216, v98, v54
v_dot2c_f32_bf16 v217, v98, v55
v_dot2c_f32_bf16 v210, v99, v52
v_dot2c_f32_bf16 v211, v99, v53
v_dot2c_f32_bf16 v218, v99, v54
v_dot2c_f32_bf16 v219, v99, v55
v_and_b32 v52, 0xffff, v57
v_lshlrev_b32 v53, 16, v57
v_and_b32 v54, 0xffff, v59
v_lshlrev_b32 v55, 16, v59
v_dot2c_f32_bf16 v140, v100, v52
v_dot2c_f32_bf16 v141, v100, v53
v_dot2c_f32_bf16 v148, v100, v54
v_dot2c_f32_bf16 v149, v100, v55
v_dot2c_f32_bf16 v142, v101, v52
v_dot2c_f32_bf16 v143, v101, v53
v_dot2c_f32_bf16 v150, v101, v54
v_dot2c_f32_bf16 v151, v101, v55
v_dot2c_f32_bf16 v144, v102, v52
v_dot2c_f32_bf16 v145, v102, v53
v_dot2c_f32_bf16 v152, v102, v54
v_dot2c_f32_bf16 v153, v102, v55
v_dot2c_f32_bf16 v146, v103, v52
v_dot2c_f32_bf16 v147, v103, v53
v_dot2c_f32_bf16 v154, v103, v54
v_dot2c_f32_bf16 v155, v103, v55
v_dot2c_f32_bf16 v156, v104, v52
v_dot2c_f32_bf16 v157, v104, v53
v_dot2c_f32_bf16 v164, v104, v54
v_dot2c_f32_bf16 v165, v104, v55
v_dot2c_f32_bf16 v158, v105, v52
v_dot2c_f32_bf16 v159, v105, v53
v_dot2c_f32_bf16 v166, v105, v54
v_dot2c_f32_bf16 v167, v105, v55
v_dot2c_f32_bf16 v160, v106, v52
v_dot2c_f32_bf16 v161, v106, v53
v_dot2c_f32_bf16 v168, v106, v54
v_dot2c_f32_bf16 v169, v106, v55
v_dot2c_f32_bf16 v162, v107, v52
v_dot2c_f32_bf16 v163, v107, v53
v_dot2c_f32_bf16 v170, v107, v54
v_dot2c_f32_bf16 v171, v107, v55
v_dot2c_f32_bf16 v172, v108, v52
v_dot2c_f32_bf16 v173, v108, v53
v_dot2c_f32_bf16 v180, v108, v54
v_dot2c_f32_bf16 v181, v108, v55
v_dot2c_f32_bf16 v174, v109, v52
v_dot2c_f32_bf16 v175, v109, v53
v_dot2c_f32_bf16 v182, v109, v54
v_dot2c_f32_bf16 v183, v109, v55
v_dot2c_f32_bf16 v176, v110, v52
v_dot2c_f32_bf16 v177, v110, v53
v_dot2c_f32_bf16 v184, v110, v54
v_dot2c_f32_bf16 v185, v110, v55
v_dot2c_f32_bf16 v178, v111, v52
v_dot2c_f32_bf16 v179, v111, v53
v_dot2c_f32_bf16 v186, v111, v54
v_dot2c_f32_bf16 v187, v111, v55
v_dot2c_f32_bf16 v188, v112, v52
v_dot2c_f32_bf16 v189, v112, v53
v_dot2c_f32_bf16 v196, v112, v54
v_dot2c_f32_bf16 v197, v112, v55
v_dot2c_f32_bf16 v190, v113, v52
v_dot2c_f32_bf16 v191, v113, v53
v_dot2c_f32_bf16 v198, v113, v54
v_dot2c_f32_bf16 v199, v113, v55
v_dot2c_f32_bf16 v192, v114, v52
v_dot2c_f32_bf16 v193, v114, v53
v_dot2c_f32_bf16 v200, v114, v54
v_dot2c_f32_bf16 v201, v114, v55
v_dot2c_f32_bf16 v194, v115, v52
v_dot2c_f32_bf16 v195, v115, v53
v_dot2c_f32_bf16 v202, v115, v54
v_dot2c_f32_bf16 v203, v115, v55
v_dot2c_f32_bf16 v204, v116, v52
v_dot2c_f32_bf16 v205, v116, v53
v_dot2c_f32_bf16 v212, v116, v54
v_dot2c_f32_bf16 v213, v116, v55
v_dot2c_f32_bf16 v206, v117, v52
v_dot2c_f32_bf16 v207, v117, v53
v_dot2c_f32_bf16 v214, v117, v54
v_dot2c_f32_bf16 v215, v117, v55
v_dot2c_f32_bf16 v208, v118, v52
v_dot2c_f32_bf16 v209, v118, v53
v_dot2c_f32_bf16 v216, v118, v54
v_dot2c_f32_bf16 v217, v118, v55
v_dot2c_f32_bf16 v210, v119, v52
v_dot2c_f32_bf16 v211, v119, v53
v_dot2c_f32_bf16 v218, v119, v54
v_dot2c_f32_bf16 v219, v119, v55
v_lshrrev_b32 v52, 16, v57
v_and_b32 v53, 0xffff0000, v57
v_lshrrev_b32 v54, 16, v59
v_and_b32 v55, 0xffff0000, v59
v_dot2c_f32_bf16 v140, v120, v52
v_dot2c_f32_bf16 v141, v120, v53
v_dot2c_f32_bf16 v148, v120, v54
v_dot2c_f32_bf16 v149, v120, v55
v_dot2c_f32_bf16 v142, v121, v52
v_dot2c_f32_bf16 v143, v121, v53
v_dot2c_f32_bf16 v150, v121, v54
v_dot2c_f32_bf16 v151, v121, v55
v_dot2c_f32_bf16 v144, v122, v52
v_dot2c_f32_bf16 v145, v122, v53
v_dot2c_f32_bf16 v152, v122, v54
v_dot2c_f32_bf16 v153, v122, v55
v_dot2c_f32_bf16 v146, v123, v52
v_dot2c_f32_bf16 v147, v123, v53
v_dot2c_f32_bf16 v154, v123, v54
v_dot2c_f32_bf16 v155, v123, v55
v_dot2c_f32_bf16 v156, v124, v52
v_dot2c_f32_bf16 v157, v124, v53
v_dot2c_f32_bf16 v164, v124, v54
v_dot2c_f32_bf16 v165, v124, v55
v_dot2c_f32_bf16 v158, v125, v52
v_dot2c_f32_bf16 v159, v125, v53
v_dot2c_f32_bf16 v166, v125, v54
v_dot2c_f32_bf16 v167, v125, v55
v_dot2c_f32_bf16 v160, v126, v52
v_dot2c_f32_bf16 v161, v126, v53
v_dot2c_f32_bf16 v168, v126, v54
v_dot2c_f32_bf16 v169, v126, v55
v_dot2c_f32_bf16 v162, v127, v52
v_dot2c_f32_bf16 v163, v127, v53
v_dot2c_f32_bf16 v170, v127, v54
v_dot2c_f32_bf16 v171, v127, v55
v_dot2c_f32_bf16 v172, v128, v52
v_dot2c_f32_bf16 v173, v128, v53
v_dot2c_f32_bf16 v180, v128, v54
v_dot2c_f32_bf16 v181, v128, v55
v_dot2c_f32_bf16 v174, v129, v52
v_dot2c_f32_bf16 v175, v129, v53
v_dot2c_f32_bf16 v182, v129, v54
v_dot2c_f32_bf16 v183, v129, v55
v_dot2c_f32_bf16 v176, v130, v52
v_dot2c_f32_bf16 v177, v130, v53
v_dot2c_f32_bf16 v184, v130, v54
v_dot2c_f32_bf16 v185, v130, v55
v_dot2c_f32_bf16 v178, v131, v52
v_dot2c_f32_bf16 v179, v131, v53
v_dot2c_f32_bf16 v186, v131, v54
v_dot2c_f32_bf16 v187, v131, v55
v_dot2c_f32_bf16 v188, v132, v52
v_dot2c_f32_bf16 v189, v132, v53
v_dot2c_f32_bf16 v196, v132, v54
v_dot2c_f32_bf16 v197, v132, v55
v_dot2c_f32_bf16 v190, v133, v52
v_dot2c_f32_bf16 v191, v133, v53
v_dot2c_f32_bf16 v198, v133, v54
v_dot2c_f32_bf16 v199, v133, v55
v_dot2c_f32_bf16 v192, v134, v52
v_dot2c_f32_bf16 v193, v134, v53
v_dot2c_f32_bf16 v200, v134, v54
v_dot2c_f32_bf16 v201, v134, v55
v_dot2c_f32_bf16 v194, v135, v52
v_dot2c_f32_bf16 v195, v135, v53
v_dot2c_f32_bf16 v202, v135, v54
v_dot2c_f32_bf16 v203, v135, v55
v_dot2c_f32_bf16 v204, v136, v52
v_dot2c_f32_bf16 v205, v136, v53
v_dot2c_f32_bf16 v212, v136, v54
v_dot2c_f32_bf16 v213, v136, v55
v_dot2c_f32_bf16 v206, v137, v52
v_dot2c_f32_bf16 v207, v137, v53
v_dot2c_f32_bf16 v214, v137, v54
v_dot2c_f32_bf16 v215, v137, v55
v_dot2c_f32_bf16 v208, v138, v52
v_dot2c_f32_bf16 v209, v138, v53
v_dot2c_f32_bf16 v216, v138, v54
v_dot2c_f32_bf16 v217, v138, v55
v_dot2c_f32_bf16 v210, v139, v52
v_dot2c_f32_bf16 v211, v139, v53
v_dot2c_f32_bf16 v218, v139, v54
v_dot2c_f32_bf16 v219, v139, v55
v_permlane32_swap_b32 v140, v148
v_permlane32_swap_b32 v141, v149
v_permlane32_swap_b32 v142, v150
v_permlane32_swap_b32 v143, v151
v_permlane32_swap_b32 v144, v152
v_permlane32_swap_b32 v145, v153
v_permlane32_swap_b32 v146, v154
v_permlane32_swap_b32 v147, v155
v_add_f32 v140, v140, v148
v_add_f32 v141, v141, v149
v_add_f32 v142, v142, v150
v_add_f32 v143, v143, v151
v_add_f32 v144, v144, v152
v_add_f32 v145, v145, v153
v_add_f32 v146, v146, v154
v_add_f32 v147, v147, v155
v_permlane16_swap_b32 v140, v144
v_permlane16_swap_b32 v141, v145
v_permlane16_swap_b32 v142, v146
v_permlane16_swap_b32 v143, v147
v_add_f32 v140, v140, v144
v_add_f32 v141, v141, v145
v_add_f32 v142, v142, v146
v_add_f32 v143, v143, v147
v_permlane32_swap_b32 v156, v164
v_permlane32_swap_b32 v157, v165
v_permlane32_swap_b32 v158, v166
v_permlane32_swap_b32 v159, v167
v_permlane32_swap_b32 v160, v168
v_permlane32_swap_b32 v161, v169
v_permlane32_swap_b32 v162, v170
v_permlane32_swap_b32 v163, v171
v_add_f32 v156, v156, v164
v_add_f32 v157, v157, v165
v_add_f32 v158, v158, v166
v_add_f32 v159, v159, v167
v_add_f32 v160, v160, v168
v_add_f32 v161, v161, v169
v_add_f32 v162, v162, v170
v_add_f32 v163, v163, v171
v_permlane16_swap_b32 v156, v160
v_permlane16_swap_b32 v157, v161
v_permlane16_swap_b32 v158, v162
v_permlane16_swap_b32 v159, v163
v_add_f32 v156, v156, v160
v_add_f32 v157, v157, v161
v_add_f32 v158, v158, v162
v_add_f32 v159, v159, v163
v_permlane32_swap_b32 v172, v180
v_permlane32_swap_b32 v173, v181
v_permlane32_swap_b32 v174, v182
v_permlane32_swap_b32 v175, v183
v_permlane32_swap_b32 v176, v184
v_permlane32_swap_b32 v177, v185
v_permlane32_swap_b32 v178, v186
v_permlane32_swap_b32 v179, v187
v_add_f32 v172, v172, v180
v_add_f32 v173, v173, v181
v_add_f32 v174, v174, v182
v_add_f32 v175, v175, v183
v_add_f32 v176, v176, v184
v_add_f32 v177, v177, v185
v_add_f32 v178, v178, v186
v_add_f32 v179, v179, v187
v_permlane16_swap_b32 v172, v176
v_permlane16_swap_b32 v173, v177
v_permlane16_swap_b32 v174, v178
v_permlane16_swap_b32 v175, v179
v_add_f32 v172, v172, v176
v_add_f32 v173, v173, v177
v_add_f32 v174, v174, v178
v_add_f32 v175, v175, v179
v_permlane32_swap_b32 v188, v196
v_permlane32_swap_b32 v189, v197
v_permlane32_swap_b32 v190, v198
v_permlane32_swap_b32 v191, v199
v_permlane32_swap_b32 v192, v200
v_permlane32_swap_b32 v193, v201
v_permlane32_swap_b32 v194, v202
v_permlane32_swap_b32 v195, v203
v_add_f32 v188, v188, v196
v_add_f32 v189, v189, v197
v_add_f32 v190, v190, v198
v_add_f32 v191, v191, v199
v_add_f32 v192, v192, v200
v_add_f32 v193, v193, v201
v_add_f32 v194, v194, v202
v_add_f32 v195, v195, v203
v_permlane16_swap_b32 v188, v192
v_permlane16_swap_b32 v189, v193
v_permlane16_swap_b32 v190, v194
v_permlane16_swap_b32 v191, v195
v_add_f32 v188, v188, v192
v_add_f32 v189, v189, v193
v_add_f32 v190, v190, v194
v_add_f32 v191, v191, v195
v_permlane32_swap_b32 v204, v212
v_permlane32_swap_b32 v205, v213
v_permlane32_swap_b32 v206, v214
v_permlane32_swap_b32 v207, v215
v_permlane32_swap_b32 v208, v216
v_permlane32_swap_b32 v209, v217
v_permlane32_swap_b32 v210, v218
v_permlane32_swap_b32 v211, v219
v_add_f32 v204, v204, v212
v_add_f32 v205, v205, v213
v_add_f32 v206, v206, v214
v_add_f32 v207, v207, v215
v_add_f32 v208, v208, v216
v_add_f32 v209, v209, v217
v_add_f32 v210, v210, v218
v_add_f32 v211, v211, v219
v_permlane16_swap_b32 v204, v208
v_permlane16_swap_b32 v205, v209
v_permlane16_swap_b32 v206, v210
v_permlane16_swap_b32 v207, v211
v_add_f32 v204, v204, v208
v_add_f32 v205, v205, v209
v_add_f32 v206, v206, v210
v_add_f32 v207, v207, v211
v_lshrrev_b32 v6, 5, v1
v_mul_u32_u24 v6, 2560, v6
v_and_b32 v7, 15, v1
v_lshl_add_u32 v6, v7, 5, v6
v_bfe_u32 v7, v1, 4, 1
v_lshl_add_u32 v6, v7, 4, v6
s_mul_i32 s62, s56, 5120
v_add_u32 v6, s62, v6
ds_write_b128 v6, v[140:143] offset:19968
ds_write_b128 v6, v[156:159] offset:20480
ds_write_b128 v6, v[172:175] offset:20992
ds_write_b128 v6, v[188:191] offset:21504
ds_write_b128 v6, v[204:207] offset:22016
s_waitcnt lgkmcnt(0)
s_barrier
s_mul_i32 s60, s61, 0x9E3779B1
s_add_u32 s60, s60, 0x7F4A7C15
s_mul_i32 s62, s57, 10240
s_add_u32 s62, s62, 1703936
v_mov_b32 v41, s60
v_mov_b32 v43, s60
v_add_u32 v5, 0, v0
v_lshlrev_b32 v6, 3, v5
ds_read_b64 v[20:21], v6 offset:19968
ds_read_b64 v[22:23], v6 offset:25088
ds_read_b64 v[24:25], v6 offset:30208
ds_read_b64 v[26:27], v6 offset:35328
s_waitcnt lgkmcnt(0)
v_add_f32 v20, v20, v22
v_add_f32 v21, v21, v23
v_add_f32 v24, v24, v26
v_add_f32 v25, v25, v27
v_add_f32 v40, v20, v24
v_add_f32 v42, v21, v25
v_lshlrev_b32 v6, 4, v5
buffer_store_dwordx4 v[40:43], v6, s[40:43], s62 offen sc0 sc1
s_nop 1
v_add_u32 v5, 256, v0
v_lshlrev_b32 v6, 3, v5
ds_read_b64 v[20:21], v6 offset:19968
ds_read_b64 v[22:23], v6 offset:25088
ds_read_b64 v[24:25], v6 offset:30208
ds_read_b64 v[26:27], v6 offset:35328
s_waitcnt lgkmcnt(0)
v_add_f32 v20, v20, v22
v_add_f32 v21, v21, v23
v_add_f32 v24, v24, v26
v_add_f32 v25, v25, v27
v_add_f32 v40, v20, v24
v_add_f32 v42, v21, v25
v_lshlrev_b32 v6, 4, v5
buffer_store_dwordx4 v[40:43], v6, s[40:43], s62 offen sc0 sc1
s_nop 1
s_cmp_ge_u32 s56, 2
s_cbranch_scc1 L_fin
v_add_u32 v5, 512, v0
v_lshlrev_b32 v6, 3, v5
ds_read_b64 v[20:21], v6 offset:19968
ds_read_b64 v[22:23], v6 offset:25088
ds_read_b64 v[24:25], v6 offset:30208
ds_read_b64 v[26:27], v6 offset:35328
s_waitcnt lgkmcnt(0)
v_add_f32 v20, v20, v22
v_add_f32 v21, v21, v23
v_add_f32 v24, v24, v26
v_add_f32 v25, v25, v27
v_add_f32 v40, v20, v24
v_add_f32 v42, v21, v25
v_lshlrev_b32 v6, 4, v5
buffer_store_dwordx4 v[40:43], v6, s[40:43], s62 offen sc0 sc1
s_nop 1
L_fin:
L_end:
s_endpgm
.section .rodata,"a"
.p2align 6
.amdhsa_kernel recurrent_scan__mha_block_cached__geglu_ffn__decode_kernel
  .amdhsa_next_free_vgpr 256
  .amdhsa_next_free_sgpr 102
  .amdhsa_accum_offset 256
  .amdhsa_group_segment_fixed_size 0
  .amdhsa_kernarg_size 96
  .amdhsa_user_sgpr_count 2
  .amdhsa_user_sgpr_kernarg_segment_ptr 1
  .amdhsa_system_sgpr_workgroup_id_x 1
.end_amdhsa_kernel
```
